```python
import torch

def _softmax(x, axis=-1):
    return torch.softmax(x, dim=axis)
def _gelu(x):
    return torch.nn.functional.gelu(x, approximate="tanh")
def _silu(x):
    return torch.nn.functional.silu(x)
def _sigmoid(x):
    return torch.sigmoid(x)
def _layernorm(x, axis=-1, eps=1e-5):
    m = x.mean(dim=axis, keepdim=True)
    v = x.var(dim=axis, keepdim=True, unbiased=False)
    return (x - m) / torch.sqrt(v + eps)
def _scatter_add(tgt, idx, src, axis=0):
    return tgt.clone().index_add_(axis, idx, src)
def _segment_sum(src, seg, n):
    out = torch.zeros((n,) + src.shape[1:], dtype=src.dtype)
    return out.index_add_(0, seg, src)
def _pad(x, pw):
    flat = tuple(v for pair in reversed(pw) for v in pair)
    return torch.nn.functional.pad(x, flat)

kernel_name = 'standalone__gqa_softmax__near_ridge'

def setup_inputs():

    _w = (lambda a: (lambda t: t.to(torch.bfloat16) if t.is_floating_point() else t)(torch.as_tensor(a)))
    B, Hq, Hkv, Sq, Sk, D = 32, 32, 32, 192, 512, 128
    return {
        "q": _w((lambda *s: torch.randn(*s, dtype=torch.bfloat16) * 0.8)(B, Hq, Sq, D)),
        "k": _w((lambda *s: torch.randn(*s, dtype=torch.bfloat16) * 0.8)(B, Hkv, Sk, D)),
        "v": _w((lambda *s: torch.randn(*s, dtype=torch.bfloat16) * 0.05)(B, Hkv, Sk, D)),
    }

def reference(q, k, v):
    B, Hq, Sq, D = q.shape
    Hkv = k.shape[1]
    rep = Hq // Hkv
    k = (lambda x, n, axis: torch.repeat_interleave(x, n, dim=axis))(k, rep, axis=1)
    v = (lambda x, n, axis: torch.repeat_interleave(x, n, dim=axis))(v, rep, axis=1)
    scale = D ** -0.5
    scores = torch.einsum("bhqd,bhkd->bhqk", q, k) * scale
    p = _softmax(scores, axis=-1)
    return torch.einsum("bhqk,bhkd->bhqd", p, v)
```

```asm
; @launch grid=(256,1,1) block=(512,1,1) lds=147712
.amdgcn_target "amdgcn-amd-amdhsa--gfx950"
.text
.globl standalone__gqa_softmax__near_ridge_kernel
.p2align 8
.type standalone__gqa_softmax__near_ridge_kernel,@function
standalone__gqa_softmax__near_ridge_kernel:
    s_cmp_ge_u32 s2, 256
    s_cbranch_scc1 L_end
    s_load_dwordx8 s[36:43], s[0:1], 0
    v_lshrrev_b32 v6, 6, v0
    v_and_b32 v255, 63, v0
    v_readfirstlane_b32 s45, v6
    v_lshrrev_b32 v1, 4, v255
    v_and_b32 v2, 15, v255
    s_mov_b32 s26, 262144
    s_nop 0
    s_and_b32 s3, s45, 3
    s_lshl_b32 s28, s3, 12
    s_cmp_lt_u32 s45, 4
    s_cbranch_scc1 L_compute
    v_and_b32 v6, 3, v6
    v_lshl_add_u32 v3, v6, 4, v1
    v_lshl_add_u32 v4, v6, 2, v1
    v_xor_b32 v4, v4, v2
    v_lshlrev_b32 v4, 4, v4
    v_lshl_add_u32 v192, v3, 8, v4
    v_and_b32 v4, 1, v6
    v_lshlrev_b32 v4, 2, v4
    v_add_u32 v4, v4, v1
    v_lshlrev_b32 v4, 1, v4
    v_xor_b32 v4, v4, v2
    v_lshlrev_b32 v4, 4, v4
    v_lshl_add_u32 v193, v3, 8, v4
    v_mul_u32_u24 v5, 12288, v6
    v_xor_b32 v4, v1, v2
    v_lshlrev_b32 v4, 4, v4
    v_lshl_add_u32 v204, v1, 8, v4
    v_xor_b32 v205, 64, v204
    v_xor_b32 v206, 128, v204
    v_xor_b32 v207, 192, v204
    v_add_u32 v200, v204, v5
    v_add_u32 v201, v205, v5
    v_add_u32 v202, v206, v5
    v_add_u32 v203, v207, v5
    v_lshl_add_u32 v194, v255, 4, v5
    v_mov_b32 v195, 147456
    s_lshl_b32 s46, s3, 2
    s_add_u32 s46, s46, 147456
    v_mov_b32 v197, s46
    s_mul_i32 s5, s2, 196608
    s_mul_i32 s6, s2, 524288
    s_mov_b32 s10, 196608
    s_mov_b32 s11, 0x20000
    s_mov_b32 s14, 524288
    s_mov_b32 s15, 0x20000
    s_mov_b32 s18, 524288
    s_mov_b32 s19, 0x20000
    s_mov_b32 s22, 196608
    s_mov_b32 s23, 0x20000
    s_mov_b32 s29, 0
    s_mov_b32 s30, 0
    s_mov_b32 s32, 0
    s_mov_b32 s34, 0
    s_mov_b32 s35, 0
    s_mov_b32 s44, 0
    s_mov_b32 s47, 0
    s_mov_b32 s33, s28
    s_mov_b32 s31, 5
    s_waitcnt lgkmcnt(0)
    s_add_u32 s8, s36, s5
    s_addc_u32 s9, s37, 0
    s_and_b32 s9, s9, 0xffff
    s_add_u32 s12, s38, s6
    s_addc_u32 s13, s39, 0
    s_and_b32 s13, s13, 0xffff
    s_add_u32 s16, s40, s6
    s_addc_u32 s17, s41, 0
    s_and_b32 s17, s17, 0xffff
    s_add_u32 s20, s42, s5
    s_addc_u32 s21, s43, 0
    s_and_b32 s21, s21, 0xffff
    s_mov_b32 s45, 0
    s_add_u32 m0, s28, 0
    s_mov_b32 s44, 0
    buffer_load_dwordx4 v200, s[8:11], s44 offen offset:0 nt lds
    buffer_load_dwordx4 v201, s[8:11], s44 offen offset:1024 nt lds
    buffer_load_dwordx4 v202, s[8:11], s44 offen offset:2048 nt lds
    buffer_load_dwordx4 v203, s[8:11], s44 offen offset:3072 nt lds
    s_add_u32 m0, s28, 16384
    s_mov_b32 s44, 4096
    buffer_load_dwordx4 v200, s[8:11], s44 offen offset:0 nt lds
    buffer_load_dwordx4 v201, s[8:11], s44 offen offset:1024 nt lds
    buffer_load_dwordx4 v202, s[8:11], s44 offen offset:2048 nt lds
    buffer_load_dwordx4 v203, s[8:11], s44 offen offset:3072 nt lds
    s_add_u32 m0, s28, 32768
    s_mov_b32 s44, 8192
    buffer_load_dwordx4 v200, s[8:11], s44 offen offset:0 nt lds
    buffer_load_dwordx4 v201, s[8:11], s44 offen offset:1024 nt lds
    buffer_load_dwordx4 v202, s[8:11], s44 offen offset:2048 nt lds
    buffer_load_dwordx4 v203, s[8:11], s44 offen offset:3072 nt lds
    s_add_u32 m0, s28, 49152
    s_nop 0
    buffer_load_dwordx4 v192, s[12:15], s34 offen offset:0 nt lds
    buffer_load_dwordx4 v192, s[12:15], s34 offen offset:1024 nt lds
    buffer_load_dwordx4 v192, s[12:15], s34 offen offset:2048 nt lds
    buffer_load_dwordx4 v192, s[12:15], s34 offen offset:3072 nt lds
    s_mov_b32 s44, 49152
    s_mov_b32 s34, 16384
    s_mov_b32 s68, 0
    s_mov_b32 s69, 0
    s_mov_b32 s29, 4
    s_mov_b32 s32, 4
    s_add_u32 s33, s28, 65536
    s_branch H_loop
L_compute:
    s_getpc_b64 s[70:71]
L_pc:
    v_lshl_add_u32 v8, v255, 6, s28
    v_min_u32 v8, L_codeend-standalone__gqa_softmax__near_ridge_kernel-4, v8
    s_sub_u32 s70, s70, L_pc-standalone__gqa_softmax__near_ridge_kernel
    s_subb_u32 s71, s71, 0
    v_mov_b32 v9, s71
    v_add_co_u32 v8, vcc, s70, v8
    s_nop 1
    v_addc_co_u32 v9, vcc, 0, v9, vcc
    global_load_dword v20, v[8:9], off
    s_setprio 1
    v_mov_b32 v10, 147456
    v_mov_b32 v12, 0
    v_mov_b32 v13, 0
    v_mov_b32 v14, 0
    v_mov_b32 v15, 0
    ds_write_b128 v10, v[12:15]
    ds_write_b128 v10, v[12:15] offset:16
    v_lshrrev_b32 v3, 2, v2
    v_and_b32 v6, 3, v2
    v_xor_b32 v4, v1, v2
    v_lshlrev_b32 v4, 4, v4
    v_lshl_add_u32 v5, v6, 8, v4
    v_lshl_add_u32 v5, v3, 12, v5
    v_add_u32 v240, 49152, v5
    v_xor_b32 v241, 64, v240
    v_xor_b32 v242, 128, v240
    v_xor_b32 v243, 192, v240
    v_and_b32 v5, 1, v1
    v_lshl_add_u32 v5, v5, 2, v3
    v_lshlrev_b32 v5, 5, v5
    v_lshl_add_u32 v5, v6, 3, v5
    v_lshl_add_u32 v5, v3, 8, v5
    v_lshl_add_u32 v5, v1, 12, v5
    v_add_u32 v244, 65536, v5
    v_xor_b32 v245, 32, v244
    v_xor_b32 v246, 64, v244
    v_xor_b32 v247, 96, v244
    v_xor_b32 v248, 128, v244
    v_xor_b32 v249, 160, v244
    v_xor_b32 v250, 192, v244
    v_xor_b32 v251, 224, v244
    s_mov_b32 s44, 0x3e0293ee
    s_mov_b32 s47, 0x44800000
    s_mov_b32 s7, 32768
    s_mov_b32 s29, 49152
    s_mov_b32 s30, 65536
    s_mov_b32 s35, -1
    s_mov_b32 s24, 3
    s_mov_b32 s25, 0
    s_lshl_b32 s27, s3, 2
    s_add_u32 s27, s27, 147472
    s_waitcnt vmcnt(0) lgkmcnt(0)
    s_barrier
    v_mov_b32 v148, 147456
L_poll1:
    ds_read_b128 v[144:147], v148
    s_waitcnt lgkmcnt(0)
    v_min3_u32 v144, v144, v145, v146
    v_min_u32 v144, v144, v147
    v_cmp_gt_u32 vcc, s24, v144
    s_nop 4
    s_cbranch_vccz L_polled1
    s_sleep 1
    s_sub_u32 s26, s26, 1
    s_cbranch_scc0 L_poll1
    s_branch L_end
L_polled1:
    s_mov_b64 s[56:57], 0
    s_mov_b32 s24, 2
    s_waitcnt lgkmcnt(0)
    s_branch L_boundary
.p2align 6
L_loop:
    ds_read_b128 v[192:195], v240 offset:0
    ds_read_b128 v[196:199], v241 offset:0
    ds_read_b128 v[200:203], v242 offset:0
    ds_read_b128 v[204:207], v243 offset:0
    ds_read_b128 v[208:211], v240 offset:1024
    ds_read_b128 v[212:215], v241 offset:1024
    ds_read_b128 v[216:219], v242 offset:1024
    ds_read_b128 v[220:223], v243 offset:1024
    s_waitcnt lgkmcnt(4)
    v_mfma_f32_16x16x32_bf16 v[144:147], v[192:195], v[96:99], 0
    s_cmp_eq_u32 s34, 7
    v_mfma_f32_16x16x32_bf16 v[144:147], v[196:199], v[100:103], v[144:147]
    s_cselect_b32 s33, 81920, s7
    v_mfma_f32_16x16x32_bf16 v[144:147], v[200:203], v[104:107], v[144:147]
    s_add_u32 s46, s29, s33
    v_mfma_f32_16x16x32_bf16 v[144:147], v[204:207], v[108:111], v[144:147]
    s_cmp_ge_u32 s46, 147456
    v_mfma_f32_16x16x32_bf16 v[160:163], v[192:195], v[112:115], 0
    s_cselect_b32 s46, 147456, 0
    v_mfma_f32_16x16x32_bf16 v[160:163], v[196:199], v[116:119], v[160:163]
    s_sub_u32 s31, s33, s46
    v_mfma_f32_16x16x32_bf16 v[160:163], v[200:203], v[120:123], v[160:163]
    s_add_u32 s29, s29, s31
    v_mfma_f32_16x16x32_bf16 v[160:163], v[204:207], v[124:127], v[160:163]
    s_add_u32 s46, s30, s33
    v_mfma_f32_16x16x32_bf16 v[176:179], v[192:195], v[128:131], 0
    s_cmp_ge_u32 s46, 147456
    v_mfma_f32_16x16x32_bf16 v[176:179], v[196:199], v[132:135], v[176:179]
    ds_read_b128 v[192:195], v240 offset:2048
    v_mfma_f32_16x16x32_bf16 v[176:179], v[200:203], v[136:139], v[176:179]
    ds_read_b128 v[196:199], v241 offset:2048
    v_mfma_f32_16x16x32_bf16 v[176:179], v[204:207], v[140:143], v[176:179]
    s_waitcnt lgkmcnt(2)
    v_mfma_f32_16x16x32_bf16 v[148:151], v[208:211], v[96:99], 0
    ds_read_b128 v[200:203], v242 offset:2048
    v_mfma_f32_16x16x32_bf16 v[148:151], v[212:215], v[100:103], v[148:151]
    ds_read_b128 v[204:207], v243 offset:2048
    v_mfma_f32_16x16x32_bf16 v[148:151], v[216:219], v[104:107], v[148:151]
    s_cselect_b32 s46, 147456, 0
    v_mfma_f32_16x16x32_bf16 v[148:151], v[220:223], v[108:111], v[148:151]
    s_sub_u32 s32, s33, s46
    v_mfma_f32_16x16x32_bf16 v[164:167], v[208:211], v[112:115], 0
    s_add_u32 s30, s30, s32
    v_mfma_f32_16x16x32_bf16 v[164:167], v[212:215], v[116:119], v[164:167]
    s_cmp_eq_u32 s34, 7
    v_mfma_f32_16x16x32_bf16 v[164:167], v[216:219], v[120:123], v[164:167]
    s_cselect_b32 s46, 5, 2
    v_mfma_f32_16x16x32_bf16 v[164:167], v[220:223], v[124:127], v[164:167]
    s_add_u32 s24, s24, s46
    v_mfma_f32_16x16x32_bf16 v[180:183], v[208:211], v[128:131], 0
    s_min_u32 s24, s24, 79
    v_mfma_f32_16x16x32_bf16 v[180:183], v[212:215], v[132:135], v[180:183]
    ds_read_b128 v[208:211], v240 offset:3072
    v_mfma_f32_16x16x32_bf16 v[180:183], v[216:219], v[136:139], v[180:183]
    ds_read_b128 v[212:215], v241 offset:3072
    v_mfma_f32_16x16x32_bf16 v[180:183], v[220:223], v[140:143], v[180:183]
    s_waitcnt lgkmcnt(2)
    v_mfma_f32_16x16x32_bf16 v[152:155], v[192:195], v[96:99], 0
    ds_read_b128 v[216:219], v242 offset:3072
    v_mfma_f32_16x16x32_bf16 v[152:155], v[196:199], v[100:103], v[152:155]
    ds_read_b128 v[220:223], v243 offset:3072
    v_mfma_f32_16x16x32_bf16 v[152:155], v[200:203], v[104:107], v[152:155]
    s_add_u32 s25, s25, 2
    v_mfma_f32_16x16x32_bf16 v[152:155], v[204:207], v[108:111], v[152:155]
    s_add_u32 s34, s34, 1
    v_mfma_f32_16x16x32_bf16 v[168:171], v[192:195], v[112:115], 0
    s_cmp_eq_u32 s34, 1
    v_mfma_f32_16x16x32_bf16 v[168:171], v[196:199], v[116:119], v[168:171]
    v_mfma_f32_16x16x32_bf16 v[168:171], v[200:203], v[120:123], v[168:171]
    v_mfma_f32_16x16x32_bf16 v[168:171], v[204:207], v[124:127], v[168:171]
    v_mfma_f32_16x16x32_bf16 v[184:187], v[192:195], v[128:131], 0
    v_mfma_f32_16x16x32_bf16 v[184:187], v[196:199], v[132:135], v[184:187]
    ds_read_b64_tr_b16 v[192:193], v244 offset:0
    v_mfma_f32_16x16x32_bf16 v[184:187], v[200:203], v[136:139], v[184:187]
    ds_read_b64_tr_b16 v[194:195], v244 offset:1024
    v_mfma_f32_16x16x32_bf16 v[184:187], v[204:207], v[140:143], v[184:187]
    s_waitcnt lgkmcnt(2)
    v_mfma_f32_16x16x32_bf16 v[156:159], v[208:211], v[96:99], 0
    ds_read_b64_tr_b16 v[196:197], v244 offset:2048
    v_mfma_f32_16x16x32_bf16 v[156:159], v[212:215], v[100:103], v[156:159]
    ds_read_b64_tr_b16 v[198:199], v244 offset:3072
    v_mfma_f32_16x16x32_bf16 v[156:159], v[216:219], v[104:107], v[156:159]
    ds_read_b64_tr_b16 v[200:201], v245 offset:0
    v_mfma_f32_16x16x32_bf16 v[156:159], v[220:223], v[108:111], v[156:159]
    ds_read_b64_tr_b16 v[202:203], v245 offset:1024
    v_mfma_f32_16x16x32_bf16 v[172:175], v[208:211], v[112:115], 0
    ds_read_b64_tr_b16 v[204:205], v245 offset:2048
    v_mfma_f32_16x16x32_bf16 v[172:175], v[212:215], v[116:119], v[172:175]
    ds_read_b64_tr_b16 v[206:207], v245 offset:3072
    v_mfma_f32_16x16x32_bf16 v[172:175], v[216:219], v[120:123], v[172:175]
    v_mfma_f32_16x16x32_bf16 v[172:175], v[220:223], v[124:127], v[172:175]
    v_mfma_f32_16x16x32_bf16 v[188:191], v[208:211], v[128:131], 0
    v_mfma_f32_16x16x32_bf16 v[188:191], v[212:215], v[132:135], v[188:191]
    s_waitcnt lgkmcnt(4)
    v_mfma_f32_16x16x32_bf16 v[188:191], v[216:219], v[136:139], v[188:191]
    ds_read_b64_tr_b16 v[208:209], v246 offset:0
    v_mfma_f32_16x16x32_bf16 v[188:191], v[220:223], v[140:143], v[188:191]
    ds_read_b64_tr_b16 v[210:211], v246 offset:1024
    ds_read_b64_tr_b16 v[212:213], v246 offset:2048
    ds_read_b64_tr_b16 v[214:215], v246 offset:3072
    ds_read_b64_tr_b16 v[216:217], v247 offset:0
    ds_read_b64_tr_b16 v[218:219], v247 offset:1024
    ds_read_b64_tr_b16 v[220:221], v247 offset:2048
    ds_read_b64_tr_b16 v[222:223], v247 offset:3072
    s_cbranch_scc1 L_firsttile
L_scale:
    v_fma_f32 v144, v144, s44, -v252
    v_fma_f32 v145, v145, s44, -v252
    v_fma_f32 v146, v146, s44, -v252
    v_fma_f32 v147, v147, s44, -v252
    v_fma_f32 v160, v160, s44, -v253
    v_fma_f32 v161, v161, s44, -v253
    v_fma_f32 v162, v162, s44, -v253
    v_fma_f32 v163, v163, s44, -v253
    v_fma_f32 v176, v176, s44, -v254
    v_fma_f32 v177, v177, s44, -v254
    v_fma_f32 v178, v178, s44, -v254
    v_fma_f32 v179, v179, s44, -v254
    v_fma_f32 v148, v148, s44, -v252
    v_fma_f32 v149, v149, s44, -v252
    v_fma_f32 v150, v150, s44, -v252
    v_fma_f32 v151, v151, s44, -v252
    v_fma_f32 v164, v164, s44, -v253
    v_fma_f32 v165, v165, s44, -v253
    v_fma_f32 v166, v166, s44, -v253
    v_fma_f32 v167, v167, s44, -v253
    v_fma_f32 v180, v180, s44, -v254
    v_fma_f32 v181, v181, s44, -v254
    v_fma_f32 v182, v182, s44, -v254
    v_fma_f32 v183, v183, s44, -v254
    v_fma_f32 v152, v152, s44, -v252
    v_fma_f32 v153, v153, s44, -v252
    v_fma_f32 v154, v154, s44, -v252
    v_fma_f32 v155, v155, s44, -v252
    v_fma_f32 v168, v168, s44, -v253
    v_fma_f32 v169, v169, s44, -v253
    v_fma_f32 v170, v170, s44, -v253
    v_fma_f32 v171, v171, s44, -v253
    v_fma_f32 v184, v184, s44, -v254
    v_fma_f32 v185, v185, s44, -v254
    v_fma_f32 v186, v186, s44, -v254
    v_fma_f32 v187, v187, s44, -v254
    v_fma_f32 v156, v156, s44, -v252
    v_fma_f32 v157, v157, s44, -v252
    v_fma_f32 v158, v158, s44, -v252
    v_fma_f32 v159, v159, s44, -v252
    v_fma_f32 v172, v172, s44, -v253
    v_fma_f32 v173, v173, s44, -v253
    v_fma_f32 v174, v174, s44, -v253
    v_fma_f32 v175, v175, s44, -v253
    v_fma_f32 v188, v188, s44, -v254
    v_fma_f32 v189, v189, s44, -v254
    v_fma_f32 v190, v190, s44, -v254
    v_fma_f32 v191, v191, s44, -v254
    v_exp_f32 v144, v144
    v_exp_f32 v145, v145
    v_exp_f32 v160, v160
    v_exp_f32 v161, v161
    v_exp_f32 v176, v176
    v_exp_f32 v177, v177
    v_exp_f32 v146, v146
    v_exp_f32 v147, v147
    v_exp_f32 v162, v162
    v_exp_f32 v163, v163
    v_add_f32 v232, v144, v146
    v_add_f32 v233, v145, v147
    v_cvt_pk_bf16_f32 v144, v144, v145
    v_cvt_pk_bf16_f32 v145, v146, v147
    v_exp_f32 v178, v178
    v_exp_f32 v179, v179
    v_add_f32 v234, v160, v162
    v_add_f32 v235, v161, v163
    v_cvt_pk_bf16_f32 v160, v160, v161
    v_cvt_pk_bf16_f32 v161, v162, v163
    v_exp_f32 v148, v148
    v_exp_f32 v149, v149
    v_add_f32 v236, v176, v178
    v_add_f32 v237, v177, v179
    v_cvt_pk_bf16_f32 v176, v176, v177
    v_cvt_pk_bf16_f32 v177, v178, v179
    v_exp_f32 v164, v164
    v_exp_f32 v165, v165
    v_add_f32 v232, v232, v148
    v_add_f32 v233, v233, v149
    v_cvt_pk_bf16_f32 v146, v148, v149
    v_exp_f32 v180, v180
    v_exp_f32 v181, v181
    v_add_f32 v234, v234, v164
    v_add_f32 v235, v235, v165
    v_cvt_pk_bf16_f32 v162, v164, v165
    v_exp_f32 v150, v150
    v_exp_f32 v151, v151
    v_add_f32 v236, v236, v180
    v_add_f32 v237, v237, v181
    v_cvt_pk_bf16_f32 v178, v180, v181
    v_exp_f32 v166, v166
    v_exp_f32 v167, v167
    v_add_f32 v232, v232, v150
    v_add_f32 v233, v233, v151
    v_cvt_pk_bf16_f32 v147, v150, v151
    v_exp_f32 v182, v182
    v_exp_f32 v183, v183
    v_add_f32 v234, v234, v166
    v_add_f32 v235, v235, v167
    v_cvt_pk_bf16_f32 v163, v166, v167
    v_exp_f32 v152, v152
    v_exp_f32 v153, v153
    v_add_f32 v236, v236, v182
    v_add_f32 v237, v237, v183
    v_cvt_pk_bf16_f32 v179, v182, v183
    v_exp_f32 v168, v168
    v_exp_f32 v169, v169
    v_add_f32 v232, v232, v152
    v_add_f32 v233, v233, v153
    v_cvt_pk_bf16_f32 v152, v152, v153
    v_exp_f32 v184, v184
    v_exp_f32 v185, v185
    v_add_f32 v234, v234, v168
    v_add_f32 v235, v235, v169
    v_cvt_pk_bf16_f32 v168, v168, v169
    v_exp_f32 v154, v154
    v_exp_f32 v155, v155
    v_add_f32 v236, v236, v184
    v_add_f32 v237, v237, v185
    v_cvt_pk_bf16_f32 v184, v184, v185
    v_exp_f32 v170, v170
    v_exp_f32 v171, v171
    v_add_f32 v232, v232, v154
    v_add_f32 v233, v233, v155
    v_cvt_pk_bf16_f32 v153, v154, v155
    v_exp_f32 v186, v186
    v_exp_f32 v187, v187
    v_add_f32 v234, v234, v170
    v_add_f32 v235, v235, v171
    v_cvt_pk_bf16_f32 v169, v170, v171
    v_exp_f32 v156, v156
    v_exp_f32 v157, v157
    v_add_f32 v236, v236, v186
    v_add_f32 v237, v237, v187
    v_cvt_pk_bf16_f32 v185, v186, v187
    v_exp_f32 v172, v172
    v_exp_f32 v173, v173
    v_add_f32 v232, v232, v156
    v_add_f32 v233, v233, v157
    v_cvt_pk_bf16_f32 v154, v156, v157
    v_exp_f32 v188, v188
    v_exp_f32 v189, v189
    v_add_f32 v234, v234, v172
    v_add_f32 v235, v235, v173
    v_cvt_pk_bf16_f32 v170, v172, v173
    v_exp_f32 v158, v158
    v_exp_f32 v159, v159
    v_add_f32 v236, v236, v188
    v_add_f32 v237, v237, v189
    v_cvt_pk_bf16_f32 v186, v188, v189
    v_exp_f32 v174, v174
    v_exp_f32 v175, v175
    v_add_f32 v232, v232, v158
    v_add_f32 v233, v233, v159
    v_cvt_pk_bf16_f32 v155, v158, v159
    v_exp_f32 v190, v190
    v_exp_f32 v191, v191
    v_add_f32 v234, v234, v174
    v_add_f32 v235, v235, v175
    v_cvt_pk_bf16_f32 v171, v174, v175
    v_add_f32 v236, v236, v190
    v_add_f32 v237, v237, v191
    v_max3_f32 v230, v232, v233, v234
    v_max3_f32 v230, v230, v235, v236
    v_max_f32 v230, v230, v237
    v_cmp_lt_f32 vcc, s47, v230
    v_cvt_pk_bf16_f32 v187, v190, v191
    s_nop 2
    s_cbranch_vccnz L_redo
    v_add_f32 v224, v224, v232
    v_add_f32 v225, v225, v233
    v_add_f32 v226, v226, v234
    v_add_f32 v227, v227, v235
    v_add_f32 v228, v228, v236
    v_add_f32 v229, v229, v237
    s_cmp_eq_u32 s34, 1
    s_cbranch_scc1 L_pv0
    v_mfma_f32_16x16x32_bf16 v[0:3], v[192:195], v[144:147], v[0:3]
    s_cmp_eq_u32 s34, 8
    v_mov_b32 v236, s27
    v_mov_b32 v237, s25
    v_mfma_f32_16x16x32_bf16 v[0:3], v[196:199], v[152:155], v[0:3]
    v_mov_b32 v238, 147456
    v_add_u32 v244, s32, v244
    v_mfma_f32_16x16x32_bf16 v[32:35], v[192:195], v[160:163], v[32:35]
    v_add_u32 v245, s32, v245
    v_add_u32 v246, s32, v246
    v_mfma_f32_16x16x32_bf16 v[32:35], v[196:199], v[168:171], v[32:35]
    v_add_u32 v247, s32, v247
    v_add_u32 v240, s31, v240
    v_mfma_f32_16x16x32_bf16 v[64:67], v[192:195], v[176:179], v[64:67]
    v_add_u32 v241, s31, v241
    v_add_u32 v242, s31, v242
    v_mfma_f32_16x16x32_bf16 v[64:67], v[196:199], v[184:187], v[64:67]
    s_waitcnt lgkmcnt(8)
    v_add_u32 v243, s31, v243
    v_mfma_f32_16x16x32_bf16 v[4:7], v[200:203], v[144:147], v[4:7]
    ds_read_b64_tr_b16 v[192:193], v248 offset:0
    v_mfma_f32_16x16x32_bf16 v[4:7], v[204:207], v[152:155], v[4:7]
    ds_read_b64_tr_b16 v[194:195], v248 offset:1024
    v_mfma_f32_16x16x32_bf16 v[36:39], v[200:203], v[160:163], v[36:39]
    ds_read_b64_tr_b16 v[196:197], v248 offset:2048
    v_mfma_f32_16x16x32_bf16 v[36:39], v[204:207], v[168:171], v[36:39]
    ds_read_b64_tr_b16 v[198:199], v248 offset:3072
    v_mfma_f32_16x16x32_bf16 v[68:71], v[200:203], v[176:179], v[68:71]
    v_mfma_f32_16x16x32_bf16 v[68:71], v[204:207], v[184:187], v[68:71]
    s_waitcnt lgkmcnt(8)
    v_mfma_f32_16x16x32_bf16 v[8:11], v[208:211], v[144:147], v[8:11]
    ds_read_b64_tr_b16 v[200:201], v249 offset:0
    v_mfma_f32_16x16x32_bf16 v[8:11], v[212:215], v[152:155], v[8:11]
    ds_read_b64_tr_b16 v[202:203], v249 offset:1024
    v_mfma_f32_16x16x32_bf16 v[40:43], v[208:211], v[160:163], v[40:43]
    ds_read_b64_tr_b16 v[204:205], v249 offset:2048
    v_mfma_f32_16x16x32_bf16 v[40:43], v[212:215], v[168:171], v[40:43]
    ds_read_b64_tr_b16 v[206:207], v249 offset:3072
    v_mfma_f32_16x16x32_bf16 v[72:75], v[208:211], v[176:179], v[72:75]
    v_mfma_f32_16x16x32_bf16 v[72:75], v[212:215], v[184:187], v[72:75]
    s_waitcnt lgkmcnt(8)
    v_mfma_f32_16x16x32_bf16 v[12:15], v[216:219], v[144:147], v[12:15]
    ds_read_b64_tr_b16 v[208:209], v250 offset:0
    v_mfma_f32_16x16x32_bf16 v[12:15], v[220:223], v[152:155], v[12:15]
    ds_read_b64_tr_b16 v[210:211], v250 offset:1024
    v_mfma_f32_16x16x32_bf16 v[44:47], v[216:219], v[160:163], v[44:47]
    ds_read_b64_tr_b16 v[212:213], v250 offset:2048
    v_mfma_f32_16x16x32_bf16 v[44:47], v[220:223], v[168:171], v[44:47]
    ds_read_b64_tr_b16 v[214:215], v250 offset:3072
    v_mfma_f32_16x16x32_bf16 v[76:79], v[216:219], v[176:179], v[76:79]
    v_mfma_f32_16x16x32_bf16 v[76:79], v[220:223], v[184:187], v[76:79]
    s_waitcnt lgkmcnt(8)
    v_mfma_f32_16x16x32_bf16 v[16:19], v[192:195], v[144:147], v[16:19]
    ds_read_b64_tr_b16 v[216:217], v251 offset:0
    v_mfma_f32_16x16x32_bf16 v[16:19], v[196:199], v[152:155], v[16:19]
    ds_read_b64_tr_b16 v[218:219], v251 offset:1024
    v_mfma_f32_16x16x32_bf16 v[48:51], v[192:195], v[160:163], v[48:51]
    ds_read_b64_tr_b16 v[220:221], v251 offset:2048
    v_mfma_f32_16x16x32_bf16 v[48:51], v[196:199], v[168:171], v[48:51]
    ds_read_b64_tr_b16 v[222:223], v251 offset:3072
    v_mfma_f32_16x16x32_bf16 v[80:83], v[192:195], v[176:179], v[80:83]
    ds_write_b32 v236, v237
    v_mfma_f32_16x16x32_bf16 v[80:83], v[196:199], v[184:187], v[80:83]
    s_waitcnt lgkmcnt(9)
    v_mfma_f32_16x16x32_bf16 v[20:23], v[200:203], v[144:147], v[20:23]
    ds_read_b128 v[232:235], v238
    v_mfma_f32_16x16x32_bf16 v[20:23], v[204:207], v[152:155], v[20:23]
    v_mfma_f32_16x16x32_bf16 v[52:55], v[200:203], v[160:163], v[52:55]
    v_add_u32 v248, s32, v248
    v_add_u32 v249, s32, v249
    v_mfma_f32_16x16x32_bf16 v[52:55], v[204:207], v[168:171], v[52:55]
    v_add_u32 v250, s32, v250
    v_add_u32 v251, s32, v251
    v_mfma_f32_16x16x32_bf16 v[84:87], v[200:203], v[176:179], v[84:87]
    v_mfma_f32_16x16x32_bf16 v[84:87], v[204:207], v[184:187], v[84:87]
    s_waitcnt lgkmcnt(6)
    v_mfma_f32_16x16x32_bf16 v[24:27], v[208:211], v[144:147], v[24:27]
    v_mfma_f32_16x16x32_bf16 v[24:27], v[212:215], v[152:155], v[24:27]
    v_mfma_f32_16x16x32_bf16 v[56:59], v[208:211], v[160:163], v[56:59]
    v_mfma_f32_16x16x32_bf16 v[56:59], v[212:215], v[168:171], v[56:59]
    v_mfma_f32_16x16x32_bf16 v[88:91], v[208:211], v[176:179], v[88:91]
    s_waitcnt lgkmcnt(0)
    v_mfma_f32_16x16x32_bf16 v[88:91], v[212:215], v[184:187], v[88:91]
    v_min3_u32 v232, v232, v233, v234
    v_min_u32 v232, v232, v235
    v_mfma_f32_16x16x32_bf16 v[28:31], v[216:219], v[144:147], v[28:31]
    v_cmp_gt_u32 s[56:57], s24, v232
    v_mfma_f32_16x16x32_bf16 v[28:31], v[220:223], v[152:155], v[28:31]
    v_mfma_f32_16x16x32_bf16 v[60:63], v[216:219], v[160:163], v[60:63]
    v_mfma_f32_16x16x32_bf16 v[60:63], v[220:223], v[168:171], v[60:63]
    v_mfma_f32_16x16x32_bf16 v[92:95], v[216:219], v[176:179], v[92:95]
    v_mfma_f32_16x16x32_bf16 v[92:95], v[220:223], v[184:187], v[92:95]
L_pvdone:
    s_waitcnt lgkmcnt(0)
    s_cbranch_scc1 L_boundary
L_next:
    s_cmp_eq_u64 s[56:57], 0
    s_cbranch_scc1 L_loop
L_wait:
    v_mov_b32 v236, 147456
L_poll2:
    ds_read_b128 v[232:235], v236
    s_waitcnt lgkmcnt(0)
    v_min3_u32 v232, v232, v233, v234
    v_min_u32 v232, v232, v235
    v_cmp_gt_u32 vcc, s24, v232
    s_nop 4
    s_cbranch_vccz L_polled2
    s_sleep 1
    s_sub_u32 s26, s26, 1
    s_cbranch_scc0 L_poll2
    s_branch L_end
L_polled2:
    s_branch L_loop
L_boundary:
    s_cmp_eq_u64 s[56:57], 0
    s_cbranch_scc1 L_qready
    v_mov_b32 v236, 147456
L_poll3:
    ds_read_b128 v[232:235], v236
    s_waitcnt lgkmcnt(0)
    v_min3_u32 v232, v232, v233, v234
    v_min_u32 v232, v232, v235
    v_cmp_gt_u32 vcc, s24, v232
    s_nop 4
    s_cbranch_vccz L_polled3
    s_sleep 1
    s_sub_u32 s26, s26, 1
    s_cbranch_scc0 L_poll3
    s_branch L_end
L_polled3:
L_qready:
    s_sub_u32 s4, s29, 49152
    s_add_u32 s4, s4, s28
    v_and_b32 v152, 15, v255
    v_lshrrev_b32 v145, 4, v255
    v_xor_b32 v145, v145, v152
    v_lshlrev_b32 v145, 4, v145
    v_lshl_add_u32 v153, v152, 8, s4
    v_add_u32 v144, v153, v145
    v_xor_b32 v145, 64, v144
    v_xor_b32 v146, 128, v144
    v_xor_b32 v147, 192, v144
    s_waitcnt lgkmcnt(2)
    ds_read_b128 v[96:99], v144 offset:0
    ds_read_b128 v[100:103], v145 offset:0
    ds_read_b128 v[104:107], v146 offset:0
    ds_read_b128 v[108:111], v147 offset:0
    ds_read_b128 v[112:115], v144 offset:16384
    ds_read_b128 v[116:119], v145 offset:16384
    ds_read_b128 v[120:123], v146 offset:16384
    ds_read_b128 v[124:127], v147 offset:16384
    ds_read_b128 v[128:131], v144 offset:32768
    ds_read_b128 v[132:135], v145 offset:32768
    ds_read_b128 v[136:139], v146 offset:32768
    ds_read_b128 v[140:143], v147 offset:32768
    s_cmp_lt_i32 s35, 0
    s_cbranch_scc1 L_first
    v_lshrrev_b32 v148, 5, v255
    v_xor_b32 v148, v148, v152
    v_lshl_add_u32 v153, v148, 4, v153
    v_bfe_u32 v148, v255, 4, 1
    v_lshl_add_u32 v232, v148, 3, v153
    v_xor_b32 v233, 32, v232
    v_xor_b32 v234, 64, v232
    v_xor_b32 v235, 96, v232
    v_xor_b32 v236, 128, v232
    v_xor_b32 v237, 160, v232
    v_xor_b32 v238, 192, v232
    v_xor_b32 v239, 224, v232
    v_add_f32 v224, v224, v225
    v_add_f32 v226, v226, v227
    v_add_f32 v228, v228, v229
    v_mov_b32 v154, v224
    v_mov_b32 v156, v226
    v_mov_b32 v158, v228
    v_permlane16_swap_b32 v224, v154
    v_permlane16_swap_b32 v226, v156
    v_permlane16_swap_b32 v228, v158
    v_add_f32 v224, v224, v154
    v_add_f32 v226, v226, v156
    v_add_f32 v228, v228, v158
    v_mov_b32 v154, v224
    v_mov_b32 v156, v226
    v_mov_b32 v158, v228
    v_permlane32_swap_b32 v224, v154
    v_permlane32_swap_b32 v226, v156
    v_permlane32_swap_b32 v228, v158
    v_add_f32 v224, v224, v154
    v_add_f32 v226, v226, v156
    v_add_f32 v228, v228, v158
    v_rcp_f32 v225, v224
    v_rcp_f32 v227, v226
    v_rcp_f32 v229, v228
    s_cmp_eq_u32 s35, 3
    s_cbranch_scc1 L_lasthead
    s_add_u32 s35, s35, 1
    s_mov_b32 s34, 0
    s_waitcnt lgkmcnt(0)
    ds_read_b128 v[192:195], v240 offset:0
    ds_read_b128 v[196:199], v241 offset:0
    ds_read_b128 v[200:203], v242 offset:0
    ds_read_b128 v[204:207], v243 offset:0
    ds_read_b128 v[208:211], v240 offset:1024
    ds_read_b128 v[212:215], v241 offset:1024
    ds_read_b128 v[216:219], v242 offset:1024
    ds_read_b128 v[220:223], v243 offset:1024
    v_mov_b32 v252, s25
    s_add_u32 s25, s25, 3
    v_mul_f32 v0, v0, v225
    v_mul_f32 v1, v1, v225
    v_mul_f32 v2, v2, v225
    v_mul_f32 v3, v3, v225
    v_cvt_pk_bf16_f32 v0, v0, v1
    v_cvt_pk_bf16_f32 v1, v2, v3
    ds_write_b64 v232, v[0:1] offset:0
    v_mul_f32 v4, v4, v225
    v_mul_f32 v5, v5, v225
    v_mul_f32 v6, v6, v225
    v_mul_f32 v7, v7, v225
    v_cvt_pk_bf16_f32 v4, v4, v5
    v_cvt_pk_bf16_f32 v5, v6, v7
    ds_write_b64 v233, v[4:5] offset:0
    s_waitcnt lgkmcnt(6)
    v_mfma_f32_16x16x32_bf16 v[144:147], v[192:195], v[96:99], 0
    s_cmp_eq_u32 s34, 7
    v_mul_f32 v8, v8, v225
    v_mul_f32 v9, v9, v225
    v_mfma_f32_16x16x32_bf16 v[144:147], v[196:199], v[100:103], v[144:147]
    s_cselect_b32 s33, 81920, s7
    v_mul_f32 v10, v10, v225
    v_mul_f32 v11, v11, v225
    v_mfma_f32_16x16x32_bf16 v[144:147], v[200:203], v[104:107], v[144:147]
    s_add_u32 s46, s29, s33
    v_cvt_pk_bf16_f32 v8, v8, v9
    v_cvt_pk_bf16_f32 v9, v10, v11
    v_mfma_f32_16x16x32_bf16 v[144:147], v[204:207], v[108:111], v[144:147]
    s_cmp_ge_u32 s46, 147456
    ds_write_b64 v234, v[8:9] offset:0
    v_mul_f32 v12, v12, v225
    v_mfma_f32_16x16x32_bf16 v[160:163], v[192:195], v[112:115], 0
    s_cselect_b32 s46, 147456, 0
    v_mul_f32 v13, v13, v225
    v_mul_f32 v14, v14, v225
    v_mfma_f32_16x16x32_bf16 v[160:163], v[196:199], v[116:119], v[160:163]
    s_sub_u32 s31, s33, s46
    v_mul_f32 v15, v15, v225
    v_cvt_pk_bf16_f32 v12, v12, v13
    v_mfma_f32_16x16x32_bf16 v[160:163], v[200:203], v[120:123], v[160:163]
    s_add_u32 s29, s29, s31
    v_cvt_pk_bf16_f32 v13, v14, v15
    ds_write_b64 v235, v[12:13] offset:0
    v_mfma_f32_16x16x32_bf16 v[160:163], v[204:207], v[124:127], v[160:163]
    s_add_u32 s46, s30, s33
    v_mul_f32 v16, v16, v225
    v_mul_f32 v17, v17, v225
    v_mfma_f32_16x16x32_bf16 v[176:179], v[192:195], v[128:131], 0
    s_cmp_ge_u32 s46, 147456
    v_mul_f32 v18, v18, v225
    v_mul_f32 v19, v19, v225
    v_mfma_f32_16x16x32_bf16 v[176:179], v[196:199], v[132:135], v[176:179]
    ds_read_b128 v[192:195], v240 offset:2048
    v_cvt_pk_bf16_f32 v16, v16, v17
    v_cvt_pk_bf16_f32 v17, v18, v19
    v_mfma_f32_16x16x32_bf16 v[176:179], v[200:203], v[136:139], v[176:179]
    ds_read_b128 v[196:199], v241 offset:2048
    ds_write_b64 v236, v[16:17] offset:0
    v_mul_f32 v20, v20, v225
    v_mfma_f32_16x16x32_bf16 v[176:179], v[204:207], v[140:143], v[176:179]
    s_waitcnt lgkmcnt(7)
    v_mul_f32 v21, v21, v225
    v_mul_f32 v22, v22, v225
    v_mfma_f32_16x16x32_bf16 v[148:151], v[208:211], v[96:99], 0
    ds_read_b128 v[200:203], v242 offset:2048
    v_mul_f32 v23, v23, v225
    v_cvt_pk_bf16_f32 v20, v20, v21
    v_mfma_f32_16x16x32_bf16 v[148:151], v[212:215], v[100:103], v[148:151]
    ds_read_b128 v[204:207], v243 offset:2048
    v_cvt_pk_bf16_f32 v21, v22, v23
    ds_write_b64 v237, v[20:21] offset:0
    v_mfma_f32_16x16x32_bf16 v[148:151], v[216:219], v[104:107], v[148:151]
    s_cselect_b32 s46, 147456, 0
    v_mul_f32 v24, v24, v225
    v_mul_f32 v25, v25, v225
    v_mfma_f32_16x16x32_bf16 v[148:151], v[220:223], v[108:111], v[148:151]
    s_sub_u32 s32, s33, s46
    v_mul_f32 v26, v26, v225
    v_mul_f32 v27, v27, v225
    v_mfma_f32_16x16x32_bf16 v[164:167], v[208:211], v[112:115], 0
    s_add_u32 s30, s30, s32
    v_cvt_pk_bf16_f32 v24, v24, v25
    v_cvt_pk_bf16_f32 v25, v26, v27
    v_mfma_f32_16x16x32_bf16 v[164:167], v[212:215], v[116:119], v[164:167]
    s_cmp_eq_u32 s34, 7
    ds_write_b64 v238, v[24:25] offset:0
    v_mul_f32 v28, v28, v225
    v_mfma_f32_16x16x32_bf16 v[164:167], v[216:219], v[120:123], v[164:167]
    s_cselect_b32 s46, 5, 2
    v_mul_f32 v29, v29, v225
    v_mul_f32 v30, v30, v225
    v_mfma_f32_16x16x32_bf16 v[164:167], v[220:223], v[124:127], v[164:167]
    s_add_u32 s24, s24, s46
    v_mul_f32 v31, v31, v225
    v_cvt_pk_bf16_f32 v28, v28, v29
    v_mfma_f32_16x16x32_bf16 v[180:183], v[208:211], v[128:131], 0
    s_min_u32 s24, s24, 79
    v_cvt_pk_bf16_f32 v29, v30, v31
    ds_write_b64 v239, v[28:29] offset:0
    v_mfma_f32_16x16x32_bf16 v[180:183], v[212:215], v[132:135], v[180:183]
    ds_read_b128 v[208:211], v240 offset:3072
    v_mov_b32 v230, s27
    v_add_u32 v231, 1, v252
    v_mfma_f32_16x16x32_bf16 v[180:183], v[216:219], v[136:139], v[180:183]
    ds_read_b128 v[212:215], v241 offset:3072
    ds_write_b32 v230, v231
    v_mul_f32 v32, v32, v227
    v_mfma_f32_16x16x32_bf16 v[180:183], v[220:223], v[140:143], v[180:183]
    s_waitcnt lgkmcnt(6)
    v_mul_f32 v33, v33, v227
    v_mul_f32 v34, v34, v227
    v_mfma_f32_16x16x32_bf16 v[152:155], v[192:195], v[96:99], 0
    ds_read_b128 v[216:219], v242 offset:3072
    v_mul_f32 v35, v35, v227
    v_cvt_pk_bf16_f32 v32, v32, v33
    v_mfma_f32_16x16x32_bf16 v[152:155], v[196:199], v[100:103], v[152:155]
    ds_read_b128 v[220:223], v243 offset:3072
    v_cvt_pk_bf16_f32 v33, v34, v35
    ds_write_b64 v232, v[32:33] offset:16384
    v_mfma_f32_16x16x32_bf16 v[152:155], v[200:203], v[104:107], v[152:155]
    s_add_u32 s25, s25, 2
    v_mul_f32 v36, v36, v227
    v_mul_f32 v37, v37, v227
    v_mfma_f32_16x16x32_bf16 v[152:155], v[204:207], v[108:111], v[152:155]
    s_add_u32 s34, s34, 1
    v_mul_f32 v38, v38, v227
    v_mul_f32 v39, v39, v227
    v_mfma_f32_16x16x32_bf16 v[168:171], v[192:195], v[112:115], 0
    s_cmp_eq_u32 s34, 1
    v_cvt_pk_bf16_f32 v36, v36, v37
    v_cvt_pk_bf16_f32 v37, v38, v39
    v_mfma_f32_16x16x32_bf16 v[168:171], v[196:199], v[116:119], v[168:171]
    ds_write_b64 v233, v[36:37] offset:16384
    v_mul_f32 v40, v40, v227
    v_mfma_f32_16x16x32_bf16 v[168:171], v[200:203], v[120:123], v[168:171]
    v_mul_f32 v41, v41, v227
    v_mul_f32 v42, v42, v227
    v_mfma_f32_16x16x32_bf16 v[168:171], v[204:207], v[124:127], v[168:171]
    v_mul_f32 v43, v43, v227
    v_cvt_pk_bf16_f32 v40, v40, v41
    v_mfma_f32_16x16x32_bf16 v[184:187], v[192:195], v[128:131], 0
    v_cvt_pk_bf16_f32 v41, v42, v43
    ds_write_b64 v234, v[40:41] offset:16384
    v_mfma_f32_16x16x32_bf16 v[184:187], v[196:199], v[132:135], v[184:187]
    ds_read_b64_tr_b16 v[192:193], v244 offset:0
    v_mul_f32 v44, v44, v227
    v_mul_f32 v45, v45, v227
    v_mfma_f32_16x16x32_bf16 v[184:187], v[200:203], v[136:139], v[184:187]
    ds_read_b64_tr_b16 v[194:195], v244 offset:1024
    v_mul_f32 v46, v46, v227
    v_mul_f32 v47, v47, v227
    v_mfma_f32_16x16x32_bf16 v[184:187], v[204:207], v[140:143], v[184:187]
    s_waitcnt lgkmcnt(5)
    v_cvt_pk_bf16_f32 v44, v44, v45
    v_cvt_pk_bf16_f32 v45, v46, v47
    v_mfma_f32_16x16x32_bf16 v[156:159], v[208:211], v[96:99], 0
    ds_read_b64_tr_b16 v[196:197], v244 offset:2048
    ds_write_b64 v235, v[44:45] offset:16384
    v_mul_f32 v48, v48, v227
    v_mfma_f32_16x16x32_bf16 v[156:159], v[212:215], v[100:103], v[156:159]
    ds_read_b64_tr_b16 v[198:199], v244 offset:3072
    v_mul_f32 v49, v49, v227
    v_mul_f32 v50, v50, v227
    v_mfma_f32_16x16x32_bf16 v[156:159], v[216:219], v[104:107], v[156:159]
    ds_read_b64_tr_b16 v[200:201], v245 offset:0
    v_mul_f32 v51, v51, v227
    v_cvt_pk_bf16_f32 v48, v48, v49
    v_mfma_f32_16x16x32_bf16 v[156:159], v[220:223], v[108:111], v[156:159]
    ds_read_b64_tr_b16 v[202:203], v245 offset:1024
    v_cvt_pk_bf16_f32 v49, v50, v51
    ds_write_b64 v236, v[48:49] offset:16384
    v_mfma_f32_16x16x32_bf16 v[172:175], v[208:211], v[112:115], 0
    ds_read_b64_tr_b16 v[204:205], v245 offset:2048
    v_mul_f32 v52, v52, v227
    v_mul_f32 v53, v53, v227
    v_mfma_f32_16x16x32_bf16 v[172:175], v[212:215], v[116:119], v[172:175]
    ds_read_b64_tr_b16 v[206:207], v245 offset:3072
    v_mul_f32 v54, v54, v227
    v_mul_f32 v55, v55, v227
    v_mfma_f32_16x16x32_bf16 v[172:175], v[216:219], v[120:123], v[172:175]
    v_cvt_pk_bf16_f32 v52, v52, v53
    v_cvt_pk_bf16_f32 v53, v54, v55
    v_mfma_f32_16x16x32_bf16 v[172:175], v[220:223], v[124:127], v[172:175]
    ds_write_b64 v237, v[52:53] offset:16384
    v_mul_f32 v56, v56, v227
    v_mfma_f32_16x16x32_bf16 v[188:191], v[208:211], v[128:131], 0
    v_mul_f32 v57, v57, v227
    v_mul_f32 v58, v58, v227
    v_mfma_f32_16x16x32_bf16 v[188:191], v[212:215], v[132:135], v[188:191]
    s_waitcnt lgkmcnt(6)
    v_mul_f32 v59, v59, v227
    v_cvt_pk_bf16_f32 v56, v56, v57
    v_mfma_f32_16x16x32_bf16 v[188:191], v[216:219], v[136:139], v[188:191]
    ds_read_b64_tr_b16 v[208:209], v246 offset:0
    v_cvt_pk_bf16_f32 v57, v58, v59
    ds_write_b64 v238, v[56:57] offset:16384
    v_mfma_f32_16x16x32_bf16 v[188:191], v[220:223], v[140:143], v[188:191]
    ds_read_b64_tr_b16 v[210:211], v246 offset:1024
    v_mul_f32 v60, v60, v227
    v_mul_f32 v61, v61, v227
    ds_read_b64_tr_b16 v[212:213], v246 offset:2048
    ds_read_b64_tr_b16 v[214:215], v246 offset:3072
    ds_read_b64_tr_b16 v[216:217], v247 offset:0
    ds_read_b64_tr_b16 v[218:219], v247 offset:1024
    ds_read_b64_tr_b16 v[220:221], v247 offset:2048
    ds_read_b64_tr_b16 v[222:223], v247 offset:3072
    v_mul_f32 v62, v62, v227
    v_mul_f32 v63, v63, v227
    v_cvt_pk_bf16_f32 v60, v60, v61
    v_cvt_pk_bf16_f32 v61, v62, v63
    s_waitcnt lgkmcnt(10)
    ds_write_b64 v239, v[60:61] offset:16384
    v_mov_b32 v230, s27
    v_add_u32 v231, 2, v252
    ds_write_b32 v230, v231
    v_mul_f32 v64, v64, v229
    v_mul_f32 v65, v65, v229
    v_mul_f32 v66, v66, v229
    v_mul_f32 v67, v67, v229
    v_cvt_pk_bf16_f32 v64, v64, v65
    v_cvt_pk_bf16_f32 v65, v66, v67
    ds_write_b64 v232, v[64:65] offset:32768
    v_mul_f32 v68, v68, v229
    v_mul_f32 v69, v69, v229
    v_mul_f32 v70, v70, v229
    v_mul_f32 v71, v71, v229
    v_cvt_pk_bf16_f32 v68, v68, v69
    v_cvt_pk_bf16_f32 v69, v70, v71
    ds_write_b64 v233, v[68:69] offset:32768
    v_mul_f32 v72, v72, v229
    v_mul_f32 v73, v73, v229
    v_mul_f32 v74, v74, v229
    v_mul_f32 v75, v75, v229
    v_cvt_pk_bf16_f32 v72, v72, v73
    v_cvt_pk_bf16_f32 v73, v74, v75
    ds_write_b64 v234, v[72:73] offset:32768
    v_mul_f32 v76, v76, v229
    v_mul_f32 v77, v77, v229
    v_mul_f32 v78, v78, v229
    v_mul_f32 v79, v79, v229
    v_cvt_pk_bf16_f32 v76, v76, v77
    v_cvt_pk_bf16_f32 v77, v78, v79
    s_waitcnt lgkmcnt(10)
    ds_write_b64 v235, v[76:77] offset:32768
    v_mul_f32 v80, v80, v229
    v_mul_f32 v81, v81, v229
    v_mul_f32 v82, v82, v229
    v_mul_f32 v83, v83, v229
    v_cvt_pk_bf16_f32 v80, v80, v81
    v_cvt_pk_bf16_f32 v81, v82, v83
    ds_write_b64 v236, v[80:81] offset:32768
    v_mul_f32 v84, v84, v229
    v_mul_f32 v85, v85, v229
    v_mul_f32 v86, v86, v229
    v_mul_f32 v87, v87, v229
    v_cvt_pk_bf16_f32 v84, v84, v85
    v_cvt_pk_bf16_f32 v85, v86, v87
    ds_write_b64 v237, v[84:85] offset:32768
    v_mul_f32 v88, v88, v229
    v_mul_f32 v89, v89, v229
    v_mul_f32 v90, v90, v229
    v_mul_f32 v91, v91, v229
    v_cvt_pk_bf16_f32 v88, v88, v89
    v_cvt_pk_bf16_f32 v89, v90, v91
    ds_write_b64 v238, v[88:89] offset:32768
    v_mul_f32 v92, v92, v229
    v_mul_f32 v93, v93, v229
    v_mul_f32 v94, v94, v229
    v_mul_f32 v95, v95, v229
    v_cvt_pk_bf16_f32 v92, v92, v93
    v_cvt_pk_bf16_f32 v93, v94, v95
    ds_write_b64 v239, v[92:93] offset:32768
    v_mov_b32 v230, s27
    v_add_u32 v231, 3, v252
    s_waitcnt lgkmcnt(10)
    ds_write_b32 v230, v231
    v_mov_b32 v224, 0
    v_mov_b32 v225, 0
    v_mov_b32 v226, 0
    v_mov_b32 v227, 0
    v_mov_b32 v228, 0
    v_mov_b32 v229, 0
    s_waitcnt lgkmcnt(0)
    s_branch L_firsttile
L_lasthead:
    s_waitcnt lgkmcnt(0)
    v_mul_f32 v0, v0, v225
    v_mul_f32 v1, v1, v225
    v_mul_f32 v2, v2, v225
    v_mul_f32 v3, v3, v225
    v_cvt_pk_bf16_f32 v0, v0, v1
    v_cvt_pk_bf16_f32 v1, v2, v3
    v_mul_f32 v4, v4, v225
    v_mul_f32 v5, v5, v225
    v_mul_f32 v6, v6, v225
    v_mul_f32 v7, v7, v225
    v_cvt_pk_bf16_f32 v4, v4, v5
    v_cvt_pk_bf16_f32 v5, v6, v7
    ds_write_b64 v232, v[0:1] offset:0
    v_mul_f32 v8, v8, v225
    v_mul_f32 v9, v9, v225
    v_mul_f32 v10, v10, v225
    v_mul_f32 v11, v11, v225
    v_cvt_pk_bf16_f32 v8, v8, v9
    v_cvt_pk_bf16_f32 v9, v10, v11
    ds_write_b64 v233, v[4:5] offset:0
    v_mul_f32 v12, v12, v225
    v_mul_f32 v13, v13, v225
    v_mul_f32 v14, v14, v225
    v_mul_f32 v15, v15, v225
    v_cvt_pk_bf16_f32 v12, v12, v13
    v_cvt_pk_bf16_f32 v13, v14, v15
    ds_write_b64 v234, v[8:9] offset:0
    v_mul_f32 v16, v16, v225
    v_mul_f32 v17, v17, v225
    v_mul_f32 v18, v18, v225
    v_mul_f32 v19, v19, v225
    v_cvt_pk_bf16_f32 v16, v16, v17
    v_cvt_pk_bf16_f32 v17, v18, v19
    ds_write_b64 v235, v[12:13] offset:0
    v_mul_f32 v20, v20, v225
    v_mul_f32 v21, v21, v225
    v_mul_f32 v22, v22, v225
    v_mul_f32 v23, v23, v225
    v_cvt_pk_bf16_f32 v20, v20, v21
    v_cvt_pk_bf16_f32 v21, v22, v23
    ds_write_b64 v236, v[16:17] offset:0
    v_mul_f32 v24, v24, v225
    v_mul_f32 v25, v25, v225
    v_mul_f32 v26, v26, v225
    v_mul_f32 v27, v27, v225
    v_cvt_pk_bf16_f32 v24, v24, v25
    v_cvt_pk_bf16_f32 v25, v26, v27
    ds_write_b64 v237, v[20:21] offset:0
    v_mul_f32 v28, v28, v225
    v_mul_f32 v29, v29, v225
    v_mul_f32 v30, v30, v225
    v_mul_f32 v31, v31, v225
    v_cvt_pk_bf16_f32 v28, v28, v29
    v_cvt_pk_bf16_f32 v29, v30, v31
    ds_write_b64 v238, v[24:25] offset:0
    s_add_u32 s25, s25, 1
    ds_write_b64 v239, v[28:29] offset:0
    v_mov_b32 v168, s27
    v_mov_b32 v169, s25
    ds_write_b32 v168, v169
    s_waitcnt lgkmcnt(4)
    v_mul_f32 v32, v32, v227
    v_mul_f32 v33, v33, v227
    v_mul_f32 v34, v34, v227
    v_mul_f32 v35, v35, v227
    v_cvt_pk_bf16_f32 v32, v32, v33
    v_cvt_pk_bf16_f32 v33, v34, v35
    v_mul_f32 v36, v36, v227
    v_mul_f32 v37, v37, v227
    v_mul_f32 v38, v38, v227
    v_mul_f32 v39, v39, v227
    v_cvt_pk_bf16_f32 v36, v36, v37
    v_cvt_pk_bf16_f32 v37, v38, v39
    ds_write_b64 v232, v[32:33] offset:16384
    v_mul_f32 v40, v40, v227
    v_mul_f32 v41, v41, v227
    v_mul_f32 v42, v42, v227
    v_mul_f32 v43, v43, v227
    v_cvt_pk_bf16_f32 v40, v40, v41
    v_cvt_pk_bf16_f32 v41, v42, v43
    ds_write_b64 v233, v[36:37] offset:16384
    v_mul_f32 v44, v44, v227
    v_mul_f32 v45, v45, v227
    v_mul_f32 v46, v46, v227
    v_mul_f32 v47, v47, v227
    v_cvt_pk_bf16_f32 v44, v44, v45
    v_cvt_pk_bf16_f32 v45, v46, v47
    ds_write_b64 v234, v[40:41] offset:16384
    v_mul_f32 v48, v48, v227
    v_mul_f32 v49, v49, v227
    v_mul_f32 v50, v50, v227
    v_mul_f32 v51, v51, v227
    v_cvt_pk_bf16_f32 v48, v48, v49
    v_cvt_pk_bf16_f32 v49, v50, v51
    ds_write_b64 v235, v[44:45] offset:16384
    v_mul_f32 v52, v52, v227
    v_mul_f32 v53, v53, v227
    v_mul_f32 v54, v54, v227
    v_mul_f32 v55, v55, v227
    v_cvt_pk_bf16_f32 v52, v52, v53
    v_cvt_pk_bf16_f32 v53, v54, v55
    ds_write_b64 v236, v[48:49] offset:16384
    v_mul_f32 v56, v56, v227
    v_mul_f32 v57, v57, v227
    v_mul_f32 v58, v58, v227
    v_mul_f32 v59, v59, v227
    v_cvt_pk_bf16_f32 v56, v56, v57
    v_cvt_pk_bf16_f32 v57, v58, v59
    ds_write_b64 v237, v[52:53] offset:16384
    v_mul_f32 v60, v60, v227
    v_mul_f32 v61, v61, v227
    v_mul_f32 v62, v62, v227
    v_mul_f32 v63, v63, v227
    v_cvt_pk_bf16_f32 v60, v60, v61
    v_cvt_pk_bf16_f32 v61, v62, v63
    ds_write_b64 v238, v[56:57] offset:16384
    s_add_u32 s25, s25, 1
    ds_write_b64 v239, v[60:61] offset:16384
    v_mov_b32 v168, s27
    v_mov_b32 v169, s25
    ds_write_b32 v168, v169
    s_waitcnt lgkmcnt(4)
    v_mul_f32 v64, v64, v229
    v_mul_f32 v65, v65, v229
    v_mul_f32 v66, v66, v229
    v_mul_f32 v67, v67, v229
    v_cvt_pk_bf16_f32 v64, v64, v65
    v_cvt_pk_bf16_f32 v65, v66, v67
    v_mul_f32 v68, v68, v229
    v_mul_f32 v69, v69, v229
    v_mul_f32 v70, v70, v229
    v_mul_f32 v71, v71, v229
    v_cvt_pk_bf16_f32 v68, v68, v69
    v_cvt_pk_bf16_f32 v69, v70, v71
    ds_write_b64 v232, v[64:65] offset:32768
    v_mul_f32 v72, v72, v229
    v_mul_f32 v73, v73, v229
    v_mul_f32 v74, v74, v229
    v_mul_f32 v75, v75, v229
    v_cvt_pk_bf16_f32 v72, v72, v73
    v_cvt_pk_bf16_f32 v73, v74, v75
    ds_write_b64 v233, v[68:69] offset:32768
    v_mul_f32 v76, v76, v229
    v_mul_f32 v77, v77, v229
    v_mul_f32 v78, v78, v229
    v_mul_f32 v79, v79, v229
    v_cvt_pk_bf16_f32 v76, v76, v77
    v_cvt_pk_bf16_f32 v77, v78, v79
    ds_write_b64 v234, v[72:73] offset:32768
    v_mul_f32 v80, v80, v229
    v_mul_f32 v81, v81, v229
    v_mul_f32 v82, v82, v229
    v_mul_f32 v83, v83, v229
    v_cvt_pk_bf16_f32 v80, v80, v81
    v_cvt_pk_bf16_f32 v81, v82, v83
    ds_write_b64 v235, v[76:77] offset:32768
    v_mul_f32 v84, v84, v229
    v_mul_f32 v85, v85, v229
    v_mul_f32 v86, v86, v229
    v_mul_f32 v87, v87, v229
    v_cvt_pk_bf16_f32 v84, v84, v85
    v_cvt_pk_bf16_f32 v85, v86, v87
    ds_write_b64 v236, v[80:81] offset:32768
    v_mul_f32 v88, v88, v229
    v_mul_f32 v89, v89, v229
    v_mul_f32 v90, v90, v229
    v_mul_f32 v91, v91, v229
    v_cvt_pk_bf16_f32 v88, v88, v89
    v_cvt_pk_bf16_f32 v89, v90, v91
    ds_write_b64 v237, v[84:85] offset:32768
    v_mul_f32 v92, v92, v229
    v_mul_f32 v93, v93, v229
    v_mul_f32 v94, v94, v229
    v_mul_f32 v95, v95, v229
    v_cvt_pk_bf16_f32 v92, v92, v93
    v_cvt_pk_bf16_f32 v93, v94, v95
    ds_write_b64 v238, v[88:89] offset:32768
    s_add_u32 s25, s25, 1
    ds_write_b64 v239, v[92:93] offset:32768
    v_mov_b32 v168, s27
    v_mov_b32 v169, s25
    ds_write_b32 v168, v169
    s_cmp_eq_u32 s35, 3
    s_cbranch_scc1 L_cend
L_newhead:
    v_mov_b64 v[224:225], 0
    v_mov_b64 v[226:227], 0
    v_mov_b64 v[228:229], 0
    s_add_u32 s35, s35, 1
    s_mov_b32 s34, 0
    s_waitcnt lgkmcnt(0)
    s_branch L_next
L_first:
    s_add_u32 s24, s24, 2
    s_mov_b64 s[56:57], 1
    s_waitcnt lgkmcnt(0)
    s_mov_b32 s25, 3
    v_mov_b32 v168, s27
    v_mov_b32 v169, s25
    ds_write_b32 v168, v169
    s_branch L_newhead
L_pv0:
    v_mfma_f32_16x16x32_bf16 v[0:3], v[192:195], v[144:147], 0
    s_cmp_eq_u32 s34, 8
    v_mov_b32 v236, s27
    v_mov_b32 v237, s25
    v_mfma_f32_16x16x32_bf16 v[0:3], v[196:199], v[152:155], v[0:3]
    v_mov_b32 v238, 147456
    v_add_u32 v244, s32, v244
    v_mfma_f32_16x16x32_bf16 v[32:35], v[192:195], v[160:163], 0
    v_add_u32 v245, s32, v245
    v_add_u32 v246, s32, v246
    v_mfma_f32_16x16x32_bf16 v[32:35], v[196:199], v[168:171], v[32:35]
    v_add_u32 v247, s32, v247
    v_add_u32 v240, s31, v240
    v_mfma_f32_16x16x32_bf16 v[64:67], v[192:195], v[176:179], 0
    v_add_u32 v241, s31, v241
    v_add_u32 v242, s31, v242
    v_mfma_f32_16x16x32_bf16 v[64:67], v[196:199], v[184:187], v[64:67]
    s_waitcnt lgkmcnt(8)
    v_add_u32 v243, s31, v243
    v_mfma_f32_16x16x32_bf16 v[4:7], v[200:203], v[144:147], 0
    ds_read_b64_tr_b16 v[192:193], v248 offset:0
    v_mfma_f32_16x16x32_bf16 v[4:7], v[204:207], v[152:155], v[4:7]
    ds_read_b64_tr_b16 v[194:195], v248 offset:1024
    v_mfma_f32_16x16x32_bf16 v[36:39], v[200:203], v[160:163], 0
    ds_read_b64_tr_b16 v[196:197], v248 offset:2048
    v_mfma_f32_16x16x32_bf16 v[36:39], v[204:207], v[168:171], v[36:39]
    ds_read_b64_tr_b16 v[198:199], v248 offset:3072
    v_mfma_f32_16x16x32_bf16 v[68:71], v[200:203], v[176:179], 0
    v_mfma_f32_16x16x32_bf16 v[68:71], v[204:207], v[184:187], v[68:71]
    s_waitcnt lgkmcnt(8)
    v_mfma_f32_16x16x32_bf16 v[8:11], v[208:211], v[144:147], 0
    ds_read_b64_tr_b16 v[200:201], v249 offset:0
    v_mfma_f32_16x16x32_bf16 v[8:11], v[212:215], v[152:155], v[8:11]
    ds_read_b64_tr_b16 v[202:203], v249 offset:1024
    v_mfma_f32_16x16x32_bf16 v[40:43], v[208:211], v[160:163], 0
    ds_read_b64_tr_b16 v[204:205], v249 offset:2048
    v_mfma_f32_16x16x32_bf16 v[40:43], v[212:215], v[168:171], v[40:43]
    ds_read_b64_tr_b16 v[206:207], v249 offset:3072
    v_mfma_f32_16x16x32_bf16 v[72:75], v[208:211], v[176:179], 0
    v_mfma_f32_16x16x32_bf16 v[72:75], v[212:215], v[184:187], v[72:75]
    s_waitcnt lgkmcnt(8)
    v_mfma_f32_16x16x32_bf16 v[12:15], v[216:219], v[144:147], 0
    ds_read_b64_tr_b16 v[208:209], v250 offset:0
    v_mfma_f32_16x16x32_bf16 v[12:15], v[220:223], v[152:155], v[12:15]
    ds_read_b64_tr_b16 v[210:211], v250 offset:1024
    v_mfma_f32_16x16x32_bf16 v[44:47], v[216:219], v[160:163], 0
    ds_read_b64_tr_b16 v[212:213], v250 offset:2048
    v_mfma_f32_16x16x32_bf16 v[44:47], v[220:223], v[168:171], v[44:47]
    ds_read_b64_tr_b16 v[214:215], v250 offset:3072
    v_mfma_f32_16x16x32_bf16 v[76:79], v[216:219], v[176:179], 0
    v_mfma_f32_16x16x32_bf16 v[76:79], v[220:223], v[184:187], v[76:79]
    s_waitcnt lgkmcnt(8)
    v_mfma_f32_16x16x32_bf16 v[16:19], v[192:195], v[144:147], 0
    ds_read_b64_tr_b16 v[216:217], v251 offset:0
    v_mfma_f32_16x16x32_bf16 v[16:19], v[196:199], v[152:155], v[16:19]
    ds_read_b64_tr_b16 v[218:219], v251 offset:1024
    v_mfma_f32_16x16x32_bf16 v[48:51], v[192:195], v[160:163], 0
    ds_read_b64_tr_b16 v[220:221], v251 offset:2048
    v_mfma_f32_16x16x32_bf16 v[48:51], v[196:199], v[168:171], v[48:51]
    ds_read_b64_tr_b16 v[222:223], v251 offset:3072
    v_mfma_f32_16x16x32_bf16 v[80:83], v[192:195], v[176:179], 0
    ds_write_b32 v236, v237
    v_mfma_f32_16x16x32_bf16 v[80:83], v[196:199], v[184:187], v[80:83]
    s_waitcnt lgkmcnt(9)
    v_mfma_f32_16x16x32_bf16 v[20:23], v[200:203], v[144:147], 0
    ds_read_b128 v[232:235], v238
    v_mfma_f32_16x16x32_bf16 v[20:23], v[204:207], v[152:155], v[20:23]
    v_mfma_f32_16x16x32_bf16 v[52:55], v[200:203], v[160:163], 0
    v_add_u32 v248, s32, v248
    v_add_u32 v249, s32, v249
    v_mfma_f32_16x16x32_bf16 v[52:55], v[204:207], v[168:171], v[52:55]
    v_add_u32 v250, s32, v250
    v_add_u32 v251, s32, v251
    v_mfma_f32_16x16x32_bf16 v[84:87], v[200:203], v[176:179], 0
    v_mfma_f32_16x16x32_bf16 v[84:87], v[204:207], v[184:187], v[84:87]
    s_waitcnt lgkmcnt(6)
    v_mfma_f32_16x16x32_bf16 v[24:27], v[208:211], v[144:147], 0
    v_mfma_f32_16x16x32_bf16 v[24:27], v[212:215], v[152:155], v[24:27]
    v_mfma_f32_16x16x32_bf16 v[56:59], v[208:211], v[160:163], 0
    v_mfma_f32_16x16x32_bf16 v[56:59], v[212:215], v[168:171], v[56:59]
    v_mfma_f32_16x16x32_bf16 v[88:91], v[208:211], v[176:179], 0
    s_waitcnt lgkmcnt(0)
    v_mfma_f32_16x16x32_bf16 v[88:91], v[212:215], v[184:187], v[88:91]
    v_min3_u32 v232, v232, v233, v234
    v_min_u32 v232, v232, v235
    v_mfma_f32_16x16x32_bf16 v[28:31], v[216:219], v[144:147], 0
    v_cmp_gt_u32 s[56:57], s24, v232
    v_mfma_f32_16x16x32_bf16 v[28:31], v[220:223], v[152:155], v[28:31]
    v_mfma_f32_16x16x32_bf16 v[60:63], v[216:219], v[160:163], 0
    v_mfma_f32_16x16x32_bf16 v[60:63], v[220:223], v[168:171], v[60:63]
    v_mfma_f32_16x16x32_bf16 v[92:95], v[216:219], v[176:179], 0
    v_mfma_f32_16x16x32_bf16 v[92:95], v[220:223], v[184:187], v[92:95]
    s_branch L_pvdone
L_firsttile:
    v_max3_f32 v232, v144, v145, v146
    v_max3_f32 v233, v160, v161, v162
    v_max3_f32 v234, v176, v177, v178
    v_max3_f32 v232, v232, v147, v148
    v_max3_f32 v233, v233, v163, v164
    v_max3_f32 v234, v234, v179, v180
    v_max3_f32 v232, v232, v149, v150
    v_max3_f32 v233, v233, v165, v166
    v_max3_f32 v234, v234, v181, v182
    v_max3_f32 v232, v232, v151, v152
    v_max3_f32 v233, v233, v167, v168
    v_max3_f32 v234, v234, v183, v184
    v_max3_f32 v232, v232, v153, v154
    v_max3_f32 v233, v233, v169, v170
    v_max3_f32 v234, v234, v185, v186
    v_max3_f32 v232, v232, v155, v156
    v_max3_f32 v233, v233, v171, v172
    v_max3_f32 v234, v234, v187, v188
    v_max3_f32 v232, v232, v157, v158
    v_max3_f32 v233, v233, v173, v174
    v_max3_f32 v234, v234, v189, v190
    v_max_f32 v232, v232, v159
    v_max_f32 v233, v233, v175
    v_max_f32 v234, v234, v191
    v_mov_b32 v236, v232
    v_mov_b32 v237, v233
    v_mov_b32 v238, v234
    v_permlane16_swap_b32 v232, v236
    v_permlane16_swap_b32 v233, v237
    v_permlane16_swap_b32 v234, v238
    v_max_f32 v232, v232, v236
    v_max_f32 v233, v233, v237
    v_max_f32 v234, v234, v238
    v_mov_b32 v236, v232
    v_mov_b32 v237, v233
    v_mov_b32 v238, v234
    v_permlane32_swap_b32 v232, v236
    v_permlane32_swap_b32 v233, v237
    v_permlane32_swap_b32 v234, v238
    v_max_f32 v232, v232, v236
    v_max_f32 v233, v233, v237
    v_max_f32 v234, v234, v238
    v_mul_f32 v252, s44, v232
    v_mul_f32 v253, s44, v233
    v_mul_f32 v254, s44, v234
    s_cmp_lg_u32 s35, 0
    s_cbranch_scc1 L_scale
    s_mov_b32 s24, 5
    v_mov_b32 v236, 147456
L_poll4:
    ds_read_b128 v[232:235], v236
    s_waitcnt lgkmcnt(0)
    v_min3_u32 v232, v232, v233, v234
    v_min_u32 v232, v232, v235
    v_cmp_gt_u32 vcc, s24, v232
    s_nop 4
    s_cbranch_vccz L_polled4
    s_sleep 1
    s_sub_u32 s26, s26, 1
    s_cbranch_scc0 L_poll4
    s_branch L_end
L_polled4:
    s_mov_b32 s24, 7
    ds_read_b64_tr_b16 v[192:193], v244 offset:0
    ds_read_b64_tr_b16 v[194:195], v244 offset:1024
    ds_read_b64_tr_b16 v[196:197], v244 offset:2048
    ds_read_b64_tr_b16 v[198:199], v244 offset:3072
    ds_read_b64_tr_b16 v[200:201], v245 offset:0
    ds_read_b64_tr_b16 v[202:203], v245 offset:1024
    ds_read_b64_tr_b16 v[204:205], v245 offset:2048
    ds_read_b64_tr_b16 v[206:207], v245 offset:3072
    s_waitcnt lgkmcnt(4)
    ds_read_b64_tr_b16 v[208:209], v246 offset:0
    ds_read_b64_tr_b16 v[210:211], v246 offset:1024
    ds_read_b64_tr_b16 v[212:213], v246 offset:2048
    ds_read_b64_tr_b16 v[214:215], v246 offset:3072
    ds_read_b64_tr_b16 v[216:217], v247 offset:0
    ds_read_b64_tr_b16 v[218:219], v247 offset:1024
    ds_read_b64_tr_b16 v[220:221], v247 offset:2048
    ds_read_b64_tr_b16 v[222:223], v247 offset:3072
    s_waitcnt lgkmcnt(0)
    s_branch L_scale
L_redo:
    s_waitcnt lgkmcnt(0)
    v_subrev_u32 v232, 0, v240
    v_subrev_u32 v233, 0, v241
    v_subrev_u32 v234, 0, v242
    v_subrev_u32 v235, 0, v243
    ds_read_b128 v[192:195], v232 offset:0
    ds_read_b128 v[196:199], v233 offset:0
    ds_read_b128 v[200:203], v234 offset:0
    ds_read_b128 v[204:207], v235 offset:0
    ds_read_b128 v[208:211], v232 offset:1024
    ds_read_b128 v[212:215], v233 offset:1024
    ds_read_b128 v[216:219], v234 offset:1024
    ds_read_b128 v[220:223], v235 offset:1024
    s_waitcnt lgkmcnt(0)
    v_mfma_f32_16x16x32_bf16 v[144:147], v[192:195], v[96:99], 0
    v_mfma_f32_16x16x32_bf16 v[144:147], v[196:199], v[100:103], v[144:147]
    v_mfma_f32_16x16x32_bf16 v[144:147], v[200:203], v[104:107], v[144:147]
    v_mfma_f32_16x16x32_bf16 v[144:147], v[204:207], v[108:111], v[144:147]
    v_mfma_f32_16x16x32_bf16 v[160:163], v[192:195], v[112:115], 0
    v_mfma_f32_16x16x32_bf16 v[160:163], v[196:199], v[116:119], v[160:163]
    v_mfma_f32_16x16x32_bf16 v[160:163], v[200:203], v[120:123], v[160:163]
    v_mfma_f32_16x16x32_bf16 v[160:163], v[204:207], v[124:127], v[160:163]
    v_mfma_f32_16x16x32_bf16 v[176:179], v[192:195], v[128:131], 0
    v_mfma_f32_16x16x32_bf16 v[176:179], v[196:199], v[132:135], v[176:179]
    v_mfma_f32_16x16x32_bf16 v[176:179], v[200:203], v[136:139], v[176:179]
    v_mfma_f32_16x16x32_bf16 v[176:179], v[204:207], v[140:143], v[176:179]
    v_mfma_f32_16x16x32_bf16 v[148:151], v[208:211], v[96:99], 0
    v_mfma_f32_16x16x32_bf16 v[148:151], v[212:215], v[100:103], v[148:151]
    v_mfma_f32_16x16x32_bf16 v[148:151], v[216:219], v[104:107], v[148:151]
    v_mfma_f32_16x16x32_bf16 v[148:151], v[220:223], v[108:111], v[148:151]
    v_mfma_f32_16x16x32_bf16 v[164:167], v[208:211], v[112:115], 0
    v_mfma_f32_16x16x32_bf16 v[164:167], v[212:215], v[116:119], v[164:167]
    v_mfma_f32_16x16x32_bf16 v[164:167], v[216:219], v[120:123], v[164:167]
    v_mfma_f32_16x16x32_bf16 v[164:167], v[220:223], v[124:127], v[164:167]
    v_mfma_f32_16x16x32_bf16 v[180:183], v[208:211], v[128:131], 0
    v_mfma_f32_16x16x32_bf16 v[180:183], v[212:215], v[132:135], v[180:183]
    v_mfma_f32_16x16x32_bf16 v[180:183], v[216:219], v[136:139], v[180:183]
    v_mfma_f32_16x16x32_bf16 v[180:183], v[220:223], v[140:143], v[180:183]
    s_nop 7
    ds_read_b128 v[192:195], v232 offset:2048
    ds_read_b128 v[196:199], v233 offset:2048
    ds_read_b128 v[200:203], v234 offset:2048
    ds_read_b128 v[204:207], v235 offset:2048
    ds_read_b128 v[208:211], v232 offset:3072
    ds_read_b128 v[212:215], v233 offset:3072
    ds_read_b128 v[216:219], v234 offset:3072
    ds_read_b128 v[220:223], v235 offset:3072
    s_waitcnt lgkmcnt(0)
    v_mfma_f32_16x16x32_bf16 v[152:155], v[192:195], v[96:99], 0
    v_mfma_f32_16x16x32_bf16 v[152:155], v[196:199], v[100:103], v[152:155]
    v_mfma_f32_16x16x32_bf16 v[152:155], v[200:203], v[104:107], v[152:155]
    v_mfma_f32_16x16x32_bf16 v[152:155], v[204:207], v[108:111], v[152:155]
    v_mfma_f32_16x16x32_bf16 v[168:171], v[192:195], v[112:115], 0
    v_mfma_f32_16x16x32_bf16 v[168:171], v[196:199], v[116:119], v[168:171]
    v_mfma_f32_16x16x32_bf16 v[168:171], v[200:203], v[120:123], v[168:171]
    v_mfma_f32_16x16x32_bf16 v[168:171], v[204:207], v[124:127], v[168:171]
    v_mfma_f32_16x16x32_bf16 v[184:187], v[192:195], v[128:131], 0
    v_mfma_f32_16x16x32_bf16 v[184:187], v[196:199], v[132:135], v[184:187]
    v_mfma_f32_16x16x32_bf16 v[184:187], v[200:203], v[136:139], v[184:187]
    v_mfma_f32_16x16x32_bf16 v[184:187], v[204:207], v[140:143], v[184:187]
    v_mfma_f32_16x16x32_bf16 v[156:159], v[208:211], v[96:99], 0
    v_mfma_f32_16x16x32_bf16 v[156:159], v[212:215], v[100:103], v[156:159]
    v_mfma_f32_16x16x32_bf16 v[156:159], v[216:219], v[104:107], v[156:159]
    v_mfma_f32_16x16x32_bf16 v[156:159], v[220:223], v[108:111], v[156:159]
    v_mfma_f32_16x16x32_bf16 v[172:175], v[208:211], v[112:115], 0
    v_mfma_f32_16x16x32_bf16 v[172:175], v[212:215], v[116:119], v[172:175]
    v_mfma_f32_16x16x32_bf16 v[172:175], v[216:219], v[120:123], v[172:175]
    v_mfma_f32_16x16x32_bf16 v[172:175], v[220:223], v[124:127], v[172:175]
    v_mfma_f32_16x16x32_bf16 v[188:191], v[208:211], v[128:131], 0
    v_mfma_f32_16x16x32_bf16 v[188:191], v[212:215], v[132:135], v[188:191]
    v_mfma_f32_16x16x32_bf16 v[188:191], v[216:219], v[136:139], v[188:191]
    v_mfma_f32_16x16x32_bf16 v[188:191], v[220:223], v[140:143], v[188:191]
    s_nop 7
    ds_read_b64_tr_b16 v[192:193], v244 offset:0
    ds_read_b64_tr_b16 v[194:195], v244 offset:1024
    ds_read_b64_tr_b16 v[196:197], v244 offset:2048
    ds_read_b64_tr_b16 v[198:199], v244 offset:3072
    ds_read_b64_tr_b16 v[200:201], v245 offset:0
    ds_read_b64_tr_b16 v[202:203], v245 offset:1024
    ds_read_b64_tr_b16 v[204:205], v245 offset:2048
    ds_read_b64_tr_b16 v[206:207], v245 offset:3072
    s_waitcnt lgkmcnt(4)
    ds_read_b64_tr_b16 v[208:209], v246 offset:0
    ds_read_b64_tr_b16 v[210:211], v246 offset:1024
    ds_read_b64_tr_b16 v[212:213], v246 offset:2048
    ds_read_b64_tr_b16 v[214:215], v246 offset:3072
    ds_read_b64_tr_b16 v[216:217], v247 offset:0
    ds_read_b64_tr_b16 v[218:219], v247 offset:1024
    ds_read_b64_tr_b16 v[220:221], v247 offset:2048
    ds_read_b64_tr_b16 v[222:223], v247 offset:3072
    v_max3_f32 v232, v144, v145, v146
    v_max3_f32 v233, v160, v161, v162
    v_max3_f32 v234, v176, v177, v178
    v_max3_f32 v232, v232, v147, v148
    v_max3_f32 v233, v233, v163, v164
    v_max3_f32 v234, v234, v179, v180
    v_max3_f32 v232, v232, v149, v150
    v_max3_f32 v233, v233, v165, v166
    v_max3_f32 v234, v234, v181, v182
    v_max3_f32 v232, v232, v151, v152
    v_max3_f32 v233, v233, v167, v168
    v_max3_f32 v234, v234, v183, v184
    v_max3_f32 v232, v232, v153, v154
    v_max3_f32 v233, v233, v169, v170
    v_max3_f32 v234, v234, v185, v186
    v_max3_f32 v232, v232, v155, v156
    v_max3_f32 v233, v233, v171, v172
    v_max3_f32 v234, v234, v187, v188
    v_max3_f32 v232, v232, v157, v158
    v_max3_f32 v233, v233, v173, v174
    v_max3_f32 v234, v234, v189, v190
    v_max_f32 v232, v232, v159
    v_max_f32 v233, v233, v175
    v_max_f32 v234, v234, v191
    v_mov_b32 v236, v232
    v_mov_b32 v237, v233
    v_mov_b32 v238, v234
    v_permlane16_swap_b32 v232, v236
    v_permlane16_swap_b32 v233, v237
    v_permlane16_swap_b32 v234, v238
    v_max_f32 v232, v232, v236
    v_max_f32 v233, v233, v237
    v_max_f32 v234, v234, v238
    v_mov_b32 v236, v232
    v_mov_b32 v237, v233
    v_mov_b32 v238, v234
    v_permlane32_swap_b32 v232, v236
    v_permlane32_swap_b32 v233, v237
    v_permlane32_swap_b32 v234, v238
    v_max_f32 v232, v232, v236
    v_max_f32 v233, v233, v237
    v_max_f32 v234, v234, v238
    v_mul_f32 v232, s44, v232
    v_mul_f32 v233, s44, v233
    v_mul_f32 v234, s44, v234
    v_max_f32 v232, v232, v252
    v_max_f32 v233, v233, v253
    v_max_f32 v234, v234, v254
    v_sub_f32 v236, v252, v232
    v_sub_f32 v237, v253, v233
    v_sub_f32 v238, v254, v234
    v_exp_f32 v236, v236
    v_exp_f32 v237, v237
    v_exp_f32 v238, v238
    v_mov_b32 v252, v232
    v_mov_b32 v253, v233
    v_mov_b32 v254, v234
    v_mul_f32 v0, v0, v236
    v_mul_f32 v1, v1, v236
    v_mul_f32 v2, v2, v236
    v_mul_f32 v3, v3, v236
    v_mul_f32 v4, v4, v236
    v_mul_f32 v5, v5, v236
    v_mul_f32 v6, v6, v236
    v_mul_f32 v7, v7, v236
    v_mul_f32 v8, v8, v236
    v_mul_f32 v9, v9, v236
    v_mul_f32 v10, v10, v236
    v_mul_f32 v11, v11, v236
    v_mul_f32 v12, v12, v236
    v_mul_f32 v13, v13, v236
    v_mul_f32 v14, v14, v236
    v_mul_f32 v15, v15, v236
    v_mul_f32 v16, v16, v236
    v_mul_f32 v17, v17, v236
    v_mul_f32 v18, v18, v236
    v_mul_f32 v19, v19, v236
    v_mul_f32 v20, v20, v236
    v_mul_f32 v21, v21, v236
    v_mul_f32 v22, v22, v236
    v_mul_f32 v23, v23, v236
    v_mul_f32 v24, v24, v236
    v_mul_f32 v25, v25, v236
    v_mul_f32 v26, v26, v236
    v_mul_f32 v27, v27, v236
    v_mul_f32 v28, v28, v236
    v_mul_f32 v29, v29, v236
    v_mul_f32 v30, v30, v236
    v_mul_f32 v31, v31, v236
    v_mul_f32 v224, v224, v236
    v_mul_f32 v225, v225, v236
    v_mul_f32 v32, v32, v237
    v_mul_f32 v33, v33, v237
    v_mul_f32 v34, v34, v237
    v_mul_f32 v35, v35, v237
    v_mul_f32 v36, v36, v237
    v_mul_f32 v37, v37, v237
    v_mul_f32 v38, v38, v237
    v_mul_f32 v39, v39, v237
    v_mul_f32 v40, v40, v237
    v_mul_f32 v41, v41, v237
    v_mul_f32 v42, v42, v237
    v_mul_f32 v43, v43, v237
    v_mul_f32 v44, v44, v237
    v_mul_f32 v45, v45, v237
    v_mul_f32 v46, v46, v237
    v_mul_f32 v47, v47, v237
    v_mul_f32 v48, v48, v237
    v_mul_f32 v49, v49, v237
    v_mul_f32 v50, v50, v237
    v_mul_f32 v51, v51, v237
    v_mul_f32 v52, v52, v237
    v_mul_f32 v53, v53, v237
    v_mul_f32 v54, v54, v237
    v_mul_f32 v55, v55, v237
    v_mul_f32 v56, v56, v237
    v_mul_f32 v57, v57, v237
    v_mul_f32 v58, v58, v237
    v_mul_f32 v59, v59, v237
    v_mul_f32 v60, v60, v237
    v_mul_f32 v61, v61, v237
    v_mul_f32 v62, v62, v237
    v_mul_f32 v63, v63, v237
    v_mul_f32 v226, v226, v237
    v_mul_f32 v227, v227, v237
    v_mul_f32 v64, v64, v238
    v_mul_f32 v65, v65, v238
    v_mul_f32 v66, v66, v238
    v_mul_f32 v67, v67, v238
    v_mul_f32 v68, v68, v238
    v_mul_f32 v69, v69, v238
    v_mul_f32 v70, v70, v238
    v_mul_f32 v71, v71, v238
    v_mul_f32 v72, v72, v238
    v_mul_f32 v73, v73, v238
    v_mul_f32 v74, v74, v238
    v_mul_f32 v75, v75, v238
    v_mul_f32 v76, v76, v238
    v_mul_f32 v77, v77, v238
    v_mul_f32 v78, v78, v238
    v_mul_f32 v79, v79, v238
    v_mul_f32 v80, v80, v238
    v_mul_f32 v81, v81, v238
    v_mul_f32 v82, v82, v238
    v_mul_f32 v83, v83, v238
    v_mul_f32 v84, v84, v238
    v_mul_f32 v85, v85, v238
    v_mul_f32 v86, v86, v238
    v_mul_f32 v87, v87, v238
    v_mul_f32 v88, v88, v238
    v_mul_f32 v89, v89, v238
    v_mul_f32 v90, v90, v238
    v_mul_f32 v91, v91, v238
    v_mul_f32 v92, v92, v238
    v_mul_f32 v93, v93, v238
    v_mul_f32 v94, v94, v238
    v_mul_f32 v95, v95, v238
    v_mul_f32 v228, v228, v238
    v_mul_f32 v229, v229, v238
    s_waitcnt lgkmcnt(0)
    s_branch L_scale
L_cend:
    s_waitcnt lgkmcnt(0)
    s_endpgm
H_loop:
    s_sub_u32 s46, s29, s30
    s_cmp_ge_u32 s46, 2
    s_cbranch_scc1 H_waitold
    s_cmp_ge_u32 s29, 80
    s_cbranch_scc1 H_blocked
    s_cmp_lt_u32 s29, s31
    s_cbranch_scc1 H_issue
    ds_read_b128 v[212:215], v195 offset:16
    s_waitcnt lgkmcnt(0)
    v_min3_u32 v212, v212, v213, v214
    v_min_u32 v212, v212, v215
    s_nop 0
    v_readfirstlane_b32 s31, v212
    s_lshr_b32 s46, s29, 2
    s_add_u32 s46, s46, 4
    s_min_u32 s46, s46, 9
    s_nop 0
    s_add_u32 s31, s31, s46
    s_cmp_lt_u32 s29, s31
    s_cbranch_scc0 H_blocked
H_issue:
    s_cmp_lt_u32 s29, 76
    s_cbranch_scc1 H_real
    s_sub_u32 s46, s29, s30
    s_cmp_gt_u32 s46, 0
    s_cbranch_scc1 H_waitold
    s_add_u32 s29, s29, 1
    s_branch H_pub
H_real:
    s_sub_u32 s46, s32, 9
    s_cmp_lt_u32 s46, 3
    s_cbranch_scc0 H_norb
    s_cmp_eq_u32 s47, 0
    s_cbranch_scc1 H_norb
    v_add_u32 v208, s33, v204
    v_add_u32 v209, s33, v205
    v_add_u32 v210, s33, v206
    v_add_u32 v211, s33, v207
    s_add_u32 s69, s69, 1
    s_mul_i32 s7, s47, 3
    s_add_u32 s46, s46, s7
    s_cmp_lg_u32 s46, 3
    s_cbranch_scc1 H_rb1
    ds_read_b128 v[0:3], v208 offset:0
    ds_read_b128 v[4:7], v209 offset:1024
    ds_read_b128 v[8:11], v210 offset:2048
    ds_read_b128 v[12:15], v211 offset:3072
    s_waitcnt lgkmcnt(0)
    s_branch H_norb
H_rb1:
    s_cmp_lg_u32 s46, 4
    s_cbranch_scc1 H_rb2
    ds_read_b128 v[16:19], v208 offset:0
    ds_read_b128 v[20:23], v209 offset:1024
    ds_read_b128 v[24:27], v210 offset:2048
    ds_read_b128 v[28:31], v211 offset:3072
    s_waitcnt lgkmcnt(0)
    s_branch H_norb
H_rb2:
    s_cmp_lg_u32 s46, 5
    s_cbranch_scc1 H_rb3
    ds_read_b128 v[32:35], v208 offset:0
    ds_read_b128 v[36:39], v209 offset:1024
    ds_read_b128 v[40:43], v210 offset:2048
    ds_read_b128 v[44:47], v211 offset:3072
    s_waitcnt lgkmcnt(0)
    s_branch H_norb
H_rb3:
    s_cmp_lg_u32 s46, 6
    s_cbranch_scc1 H_rb4
    ds_read_b128 v[48:51], v208 offset:0
    ds_read_b128 v[52:55], v209 offset:1024
    ds_read_b128 v[56:59], v210 offset:2048
    ds_read_b128 v[60:63], v211 offset:3072
    s_waitcnt lgkmcnt(0)
    s_branch H_norb
H_rb4:
    s_cmp_lg_u32 s46, 7
    s_cbranch_scc1 H_rb5
    ds_read_b128 v[64:67], v208 offset:0
    ds_read_b128 v[68:71], v209 offset:1024
    ds_read_b128 v[72:75], v210 offset:2048
    ds_read_b128 v[76:79], v211 offset:3072
    s_waitcnt lgkmcnt(0)
    s_branch H_norb
H_rb5:
    s_cmp_lg_u32 s46, 8
    s_cbranch_scc1 H_rb6
    ds_read_b128 v[80:83], v208 offset:0
    ds_read_b128 v[84:87], v209 offset:1024
    ds_read_b128 v[88:91], v210 offset:2048
    ds_read_b128 v[92:95], v211 offset:3072
    s_waitcnt lgkmcnt(0)
    s_branch H_norb
H_rb6:
    s_cmp_lg_u32 s46, 9
    s_cbranch_scc1 H_rb7
    ds_read_b128 v[96:99], v208 offset:0
    ds_read_b128 v[100:103], v209 offset:1024
    ds_read_b128 v[104:107], v210 offset:2048
    ds_read_b128 v[108:111], v211 offset:3072
    s_waitcnt lgkmcnt(0)
    s_branch H_norb
H_rb7:
    s_cmp_lg_u32 s46, 10
    s_cbranch_scc1 H_rb8
    ds_read_b128 v[112:115], v208 offset:0
    ds_read_b128 v[116:119], v209 offset:1024
    ds_read_b128 v[120:123], v210 offset:2048
    ds_read_b128 v[124:127], v211 offset:3072
    s_waitcnt lgkmcnt(0)
    s_branch H_norb
H_rb8:
    ds_read_b128 v[128:131], v208 offset:0
    ds_read_b128 v[132:135], v209 offset:1024
    ds_read_b128 v[136:139], v210 offset:2048
    ds_read_b128 v[140:143], v211 offset:3072
    s_waitcnt lgkmcnt(0)
H_norb:
    s_mov_b32 m0, s33
    s_cmp_lt_u32 s32, 3
    s_cbranch_scc1 H_q
    s_sub_u32 s7, s29, 5
    s_cmp_lt_u32 s7, 10
    s_cbranch_scc0 H_free
    s_bitcmp1_b32 s32, 0
    s_cbranch_scc0 H_vg
    s_waitcnt vmcnt(3)
    buffer_load_dwordx4 v192, s[12:15], s34 offen offset:0 nt lds
    s_waitcnt vmcnt(3)
    buffer_load_dwordx4 v192, s[12:15], s34 offen offset:1024 nt lds
    s_waitcnt vmcnt(3)
    buffer_load_dwordx4 v192, s[12:15], s34 offen offset:2048 nt lds
    s_waitcnt vmcnt(3)
    buffer_load_dwordx4 v192, s[12:15], s34 offen offset:3072 nt lds
    s_add_u32 s34, s34, 16384
    s_branch H_issued
H_vg:
    s_waitcnt vmcnt(3)
    buffer_load_dwordx4 v193, s[16:19], s35 offen offset:0 nt lds
    s_waitcnt vmcnt(3)
    buffer_load_dwordx4 v193, s[16:19], s35 offen offset:1024 nt lds
    s_waitcnt vmcnt(3)
    buffer_load_dwordx4 v193, s[16:19], s35 offen offset:2048 nt lds
    s_waitcnt vmcnt(3)
    buffer_load_dwordx4 v193, s[16:19], s35 offen offset:3072 nt lds
    s_add_u32 s35, s35, 16384
    s_branch H_issued
H_free:
    s_bitcmp1_b32 s32, 0
    s_cbranch_scc0 H_v
    s_waitcnt vmcnt(5)
    buffer_load_dwordx4 v192, s[12:15], s34 offen offset:0 nt lds
    s_waitcnt vmcnt(5)
    buffer_load_dwordx4 v192, s[12:15], s34 offen offset:1024 nt lds
    s_waitcnt vmcnt(5)
    buffer_load_dwordx4 v192, s[12:15], s34 offen offset:2048 nt lds
    s_waitcnt vmcnt(5)
    buffer_load_dwordx4 v192, s[12:15], s34 offen offset:3072 nt lds
    s_add_u32 s34, s34, 16384
    s_branch H_issued
H_v:
    s_waitcnt vmcnt(5)
    buffer_load_dwordx4 v193, s[16:19], s35 offen offset:0 nt lds
    s_waitcnt vmcnt(5)
    buffer_load_dwordx4 v193, s[16:19], s35 offen offset:1024 nt lds
    s_waitcnt vmcnt(5)
    buffer_load_dwordx4 v193, s[16:19], s35 offen offset:2048 nt lds
    s_waitcnt vmcnt(5)
    buffer_load_dwordx4 v193, s[16:19], s35 offen offset:3072 nt lds
    s_add_u32 s35, s35, 16384
    s_branch H_issued
H_q:
    s_waitcnt vmcnt(5)
    buffer_load_dwordx4 v200, s[8:11], s44 offen offset:0 nt lds
    s_waitcnt vmcnt(5)
    buffer_load_dwordx4 v201, s[8:11], s44 offen offset:1024 nt lds
    s_waitcnt vmcnt(5)
    buffer_load_dwordx4 v202, s[8:11], s44 offen offset:2048 nt lds
    s_waitcnt vmcnt(5)
    buffer_load_dwordx4 v203, s[8:11], s44 offen offset:3072 nt lds
    s_cmp_eq_u32 s32, 2
    s_cselect_b32 s46, 36864, 0
    s_add_u32 s44, s44, 4096
    s_add_u32 s44, s44, s46
H_issued:
    s_add_u32 s29, s29, 1
    s_add_u32 s32, s32, 1
    s_cmp_eq_u32 s32, 19
    s_cselect_b32 s32, 0, s32
    s_addc_u32 s47, s47, 0
    s_add_u32 s33, s33, 16384
    s_sub_u32 s46, s33, 147456
    s_min_u32 s33, s33, s46
    s_branch H_loop
H_blocked:
    s_sub_u32 s46, s29, s30
    s_cmp_gt_u32 s46, 0
    s_cbranch_scc1 H_waitold
    s_cmp_lt_u32 s29, 76
    s_cbranch_scc1 H_nap
    s_cmp_lt_u32 s68, s69
    s_cbranch_scc1 H_opp
    s_cmp_ge_u32 s29, 80
    s_cbranch_scc1 H_stores
H_nap:
    s_sleep 6
    s_sub_u32 s26, s26, 1
    s_cbranch_scc0 H_loop
    s_branch L_end
H_waitold:
    s_cmp_lt_u32 s46, 4
    s_cbranch_scc1 H_wo3
    s_waitcnt vmcnt(12)
    s_branch H_pub
H_wo3:
    s_cmp_lt_u32 s46, 3
    s_cbranch_scc1 H_wo2
    s_waitcnt vmcnt(8)
    s_branch H_pub
H_wo2:
    s_cmp_lt_u32 s46, 2
    s_cbranch_scc1 H_wo1
    s_waitcnt vmcnt(4)
    s_branch H_pub
H_wo1:
    s_waitcnt vmcnt(0)
H_pub:
    s_add_u32 s30, s30, 1
    s_cmp_lg_u32 s45, 0
    s_cbranch_scc1 H_pub2
    s_barrier
    s_mov_b32 s45, 1
H_pub2:
    v_mov_b32 v196, s30
    ds_write_b32 v197, v196
    s_branch H_loop
H_opp:
    s_add_u32 s68, s68, 1
    s_cmp_lg_u32 s68, 1
    s_cbranch_scc1 H_opp1
    s_mov_b32 s46, 0
    buffer_store_dwordx4 v[0:3], v194, s[20:23], s46 offen offset:0 sc0 sc1
    buffer_store_dwordx4 v[4:7], v194, s[20:23], s46 offen offset:1024 sc0 sc1
    buffer_store_dwordx4 v[8:11], v194, s[20:23], s46 offen offset:2048 sc0 sc1
    buffer_store_dwordx4 v[12:15], v194, s[20:23], s46 offen offset:3072 sc0 sc1
    s_branch H_loop
H_opp1:
    s_cmp_lg_u32 s68, 2
    s_cbranch_scc1 H_opp2
    s_mov_b32 s46, 4096
    buffer_store_dwordx4 v[16:19], v194, s[20:23], s46 offen offset:0 sc0 sc1
    buffer_store_dwordx4 v[20:23], v194, s[20:23], s46 offen offset:1024 sc0 sc1
    buffer_store_dwordx4 v[24:27], v194, s[20:23], s46 offen offset:2048 sc0 sc1
    buffer_store_dwordx4 v[28:31], v194, s[20:23], s46 offen offset:3072 sc0 sc1
    s_branch H_loop
H_opp2:
    s_cmp_lg_u32 s68, 3
    s_cbranch_scc1 H_opp3
    s_mov_b32 s46, 8192
    buffer_store_dwordx4 v[32:35], v194, s[20:23], s46 offen offset:0 sc0 sc1
    buffer_store_dwordx4 v[36:39], v194, s[20:23], s46 offen offset:1024 sc0 sc1
    buffer_store_dwordx4 v[40:43], v194, s[20:23], s46 offen offset:2048 sc0 sc1
    buffer_store_dwordx4 v[44:47], v194, s[20:23], s46 offen offset:3072 sc0 sc1
    s_branch H_loop
H_opp3:
    s_cmp_lg_u32 s68, 4
    s_cbranch_scc1 H_opp4
    s_mov_b32 s46, 49152
    buffer_store_dwordx4 v[48:51], v194, s[20:23], s46 offen offset:0 sc0 sc1
    buffer_store_dwordx4 v[52:55], v194, s[20:23], s46 offen offset:1024 sc0 sc1
    buffer_store_dwordx4 v[56:59], v194, s[20:23], s46 offen offset:2048 sc0 sc1
    buffer_store_dwordx4 v[60:63], v194, s[20:23], s46 offen offset:3072 sc0 sc1
    s_branch H_loop
H_opp4:
    s_cmp_lg_u32 s68, 5
    s_cbranch_scc1 H_opp5
    s_mov_b32 s46, 53248
    buffer_store_dwordx4 v[64:67], v194, s[20:23], s46 offen offset:0 sc0 sc1
    buffer_store_dwordx4 v[68:71], v194, s[20:23], s46 offen offset:1024 sc0 sc1
    buffer_store_dwordx4 v[72:75], v194, s[20:23], s46 offen offset:2048 sc0 sc1
    buffer_store_dwordx4 v[76:79], v194, s[20:23], s46 offen offset:3072 sc0 sc1
    s_branch H_loop
H_opp5:
    s_cmp_lg_u32 s68, 6
    s_cbranch_scc1 H_opp6
    s_mov_b32 s46, 57344
    buffer_store_dwordx4 v[80:83], v194, s[20:23], s46 offen offset:0 sc0 sc1
    buffer_store_dwordx4 v[84:87], v194, s[20:23], s46 offen offset:1024 sc0 sc1
    buffer_store_dwordx4 v[88:91], v194, s[20:23], s46 offen offset:2048 sc0 sc1
    buffer_store_dwordx4 v[92:95], v194, s[20:23], s46 offen offset:3072 sc0 sc1
    s_branch H_loop
H_opp6:
    s_cmp_lg_u32 s68, 7
    s_cbranch_scc1 H_opp7
    s_mov_b32 s46, 98304
    buffer_store_dwordx4 v[96:99], v194, s[20:23], s46 offen offset:0 sc0 sc1
    buffer_store_dwordx4 v[100:103], v194, s[20:23], s46 offen offset:1024 sc0 sc1
    buffer_store_dwordx4 v[104:107], v194, s[20:23], s46 offen offset:2048 sc0 sc1
    buffer_store_dwordx4 v[108:111], v194, s[20:23], s46 offen offset:3072 sc0 sc1
    s_branch H_loop
H_opp7:
    s_cmp_lg_u32 s68, 8
    s_cbranch_scc1 H_opp8
    s_mov_b32 s46, 102400
    buffer_store_dwordx4 v[112:115], v194, s[20:23], s46 offen offset:0 sc0 sc1
    buffer_store_dwordx4 v[116:119], v194, s[20:23], s46 offen offset:1024 sc0 sc1
    buffer_store_dwordx4 v[120:123], v194, s[20:23], s46 offen offset:2048 sc0 sc1
    buffer_store_dwordx4 v[124:127], v194, s[20:23], s46 offen offset:3072 sc0 sc1
    s_branch H_loop
H_opp8:
    s_mov_b32 s46, 106496
    buffer_store_dwordx4 v[128:131], v194, s[20:23], s46 offen offset:0 sc0 sc1
    buffer_store_dwordx4 v[132:135], v194, s[20:23], s46 offen offset:1024 sc0 sc1
    buffer_store_dwordx4 v[136:139], v194, s[20:23], s46 offen offset:2048 sc0 sc1
    buffer_store_dwordx4 v[140:143], v194, s[20:23], s46 offen offset:3072 sc0 sc1
    s_branch H_loop
H_stores:
    v_add_u32 v196, 16, v197
    s_add_u32 s46, s28, 65536
    v_add_u32 v208, s46, v204
    v_add_u32 v209, s46, v205
    v_add_u32 v210, s46, v206
    v_add_u32 v211, s46, v207
H_last0:
    ds_read_b32 v212, v196
    s_waitcnt lgkmcnt(0)
    v_readfirstlane_b32 s31, v212
    s_nop 3
    s_cmp_ge_u32 s31, 77
    s_cbranch_scc1 H_fin0
    s_sleep 1
    s_sub_u32 s26, s26, 1
    s_cbranch_scc0 H_last0
    s_branch L_end
H_fin0:
    ds_read_b128 v[144:147], v208 offset:0
    ds_read_b128 v[148:151], v209 offset:1024
    ds_read_b128 v[152:155], v210 offset:2048
    ds_read_b128 v[156:159], v211 offset:3072
    s_mov_b32 s46, 147456
    s_waitcnt lgkmcnt(3)
    buffer_store_dwordx4 v[144:147], v194, s[20:23], s46 offen offset:0 sc0 sc1
    s_waitcnt lgkmcnt(2)
    buffer_store_dwordx4 v[148:151], v194, s[20:23], s46 offen offset:1024 sc0 sc1
    s_waitcnt lgkmcnt(1)
    buffer_store_dwordx4 v[152:155], v194, s[20:23], s46 offen offset:2048 sc0 sc1
    s_waitcnt lgkmcnt(0)
    buffer_store_dwordx4 v[156:159], v194, s[20:23], s46 offen offset:3072 sc0 sc1
    s_add_u32 s46, s28, 81920
    v_add_u32 v208, s46, v204
    v_add_u32 v209, s46, v205
    v_add_u32 v210, s46, v206
    v_add_u32 v211, s46, v207
H_last1:
    ds_read_b32 v212, v196
    s_waitcnt lgkmcnt(0)
    v_readfirstlane_b32 s31, v212
    s_nop 3
    s_cmp_ge_u32 s31, 78
    s_cbranch_scc1 H_fin1
    s_sleep 1
    s_sub_u32 s26, s26, 1
    s_cbranch_scc0 H_last1
    s_branch L_end
H_fin1:
    ds_read_b128 v[160:163], v208 offset:0
    ds_read_b128 v[164:167], v209 offset:1024
    ds_read_b128 v[168:171], v210 offset:2048
    ds_read_b128 v[172:175], v211 offset:3072
    s_mov_b32 s46, 151552
    s_waitcnt lgkmcnt(3)
    buffer_store_dwordx4 v[160:163], v194, s[20:23], s46 offen offset:0 sc0 sc1
    s_waitcnt lgkmcnt(2)
    buffer_store_dwordx4 v[164:167], v194, s[20:23], s46 offen offset:1024 sc0 sc1
    s_waitcnt lgkmcnt(1)
    buffer_store_dwordx4 v[168:171], v194, s[20:23], s46 offen offset:2048 sc0 sc1
    s_waitcnt lgkmcnt(0)
    buffer_store_dwordx4 v[172:175], v194, s[20:23], s46 offen offset:3072 sc0 sc1
    s_add_u32 s46, s28, 98304
    v_add_u32 v208, s46, v204
    v_add_u32 v209, s46, v205
    v_add_u32 v210, s46, v206
    v_add_u32 v211, s46, v207
H_last2:
    ds_read_b32 v212, v196
    s_waitcnt lgkmcnt(0)
    v_readfirstlane_b32 s31, v212
    s_nop 3
    s_cmp_ge_u32 s31, 79
    s_cbranch_scc1 H_fin2
    s_sleep 1
    s_sub_u32 s26, s26, 1
    s_cbranch_scc0 H_last2
    s_branch L_end
H_fin2:
    ds_read_b128 v[176:179], v208 offset:0
    ds_read_b128 v[180:183], v209 offset:1024
    ds_read_b128 v[184:187], v210 offset:2048
    ds_read_b128 v[188:191], v211 offset:3072
    s_mov_b32 s46, 155648
    s_waitcnt lgkmcnt(3)
    buffer_store_dwordx4 v[176:179], v194, s[20:23], s46 offen offset:0 sc0 sc1
    s_waitcnt lgkmcnt(2)
    buffer_store_dwordx4 v[180:183], v194, s[20:23], s46 offen offset:1024 sc0 sc1
    s_waitcnt lgkmcnt(1)
    buffer_store_dwordx4 v[184:187], v194, s[20:23], s46 offen offset:2048 sc0 sc1
    s_waitcnt lgkmcnt(0)
    buffer_store_dwordx4 v[188:191], v194, s[20:23], s46 offen offset:3072 sc0 sc1
    s_waitcnt vmcnt(0)
L_end:
    s_endpgm
L_codeend:
.section .rodata,"a"
.p2align 6
.amdhsa_kernel standalone__gqa_softmax__near_ridge_kernel
  .amdhsa_next_free_vgpr 256
  .amdhsa_next_free_sgpr 88
  .amdhsa_accum_offset 256
  .amdhsa_group_segment_fixed_size 0
  .amdhsa_kernarg_size 48
  .amdhsa_user_sgpr_count 2
  .amdhsa_user_sgpr_kernarg_segment_ptr 1
  .amdhsa_system_sgpr_workgroup_id_x 1
.end_amdhsa_kernel
```
